```python
import torch

def _softmax(x, axis=-1):
    return torch.softmax(x, dim=axis)
def _gelu(x):
    return torch.nn.functional.gelu(x, approximate="tanh")
def _silu(x):
    return torch.nn.functional.silu(x)
def _sigmoid(x):
    return torch.sigmoid(x)
def _layernorm(x, axis=-1, eps=1e-5):
    m = x.mean(dim=axis, keepdim=True)
    v = x.var(dim=axis, keepdim=True, unbiased=False)
    return (x - m) / torch.sqrt(v + eps)
def _scatter_add(tgt, idx, src, axis=0):
    return tgt.clone().index_add_(axis, idx, src)
def _segment_sum(src, seg, n):
    out = torch.zeros((n,) + src.shape[1:], dtype=src.dtype)
    return out.index_add_(0, seg, src)
def _pad(x, pw):
    flat = tuple(v for pair in reversed(pw) for v in pair)
    return torch.nn.functional.pad(x, flat)

kernel_name = 'gather_scatter__molecular_angular_gemnet__graph'

def setup_inputs():

    _w = (lambda a: (lambda t: t.to(torch.bfloat16) if t.is_floating_point() else t)(torch.as_tensor(a)))
    N, deg, De, L = 10000, 32, 4, 3
    E = N * deg
    T = E * deg
    NR = 8
    dist = torch.rand(E).to(float)
    angle = (torch.rand(T) * torch.pi).to(float)
    centers = torch.linspace(0.0, 1.0, NR).to(float)
    ang_freq = torch.arange(1, L + 1).to(float)
    return {
        "m": _w((lambda *s: torch.randn(*s, dtype=torch.bfloat16) * 0.05)(E, De)),
        "idx_in": _w((lambda lo, hi, *s: torch.randint(lo, hi, s))(0, E, T).to(torch.int64)),
        "idx_out": _w((lambda lo, hi, *s: torch.randint(lo, hi, s))(0, E, T).to(torch.int64)),
        "dist": _w(dist),
        "angle": _w(angle),
        "centers": _w(centers),
        "ang_freq": _w(ang_freq),
        "w_rbf": _w((lambda *s: torch.randn(*s, dtype=torch.bfloat16) * 0.2)(NR, De)),
        "w_sbf": _w((lambda *s: torch.randn(*s, dtype=torch.bfloat16) * 0.2)(NR * L, De)),
        "w_down": _w((lambda *s: torch.randn(*s, dtype=torch.bfloat16) * 0.2)(De, De)),
        "w_up": _w((lambda *s: torch.randn(*s, dtype=torch.bfloat16) * 0.2)(De, De)),
    }

def reference(m, idx_in, idx_out, dist, angle, centers, ang_freq, w_rbf, w_sbf, w_down, w_up):
    E, De = m.shape[0], m.shape[1]
    NR = centers.shape[0]
    L = ang_freq.shape[0]
    rbf = torch.exp(-10.0 * (dist[:, None] - centers[None, :]) ** 2)
    cbf = torch.cos(ang_freq[None, :] * angle[:, None])
    rbf_t = rbf[idx_out]
    sbf = torch.reshape(rbf_t[:, :, None] * cbf[:, None, :], (-1, NR * L))
    x = (m[idx_in] @ w_down) * (sbf @ w_sbf)
    agg = _segment_sum(x, idx_out, E)
    return m + (agg @ w_up) * (rbf @ w_rbf)
```

```asm
; @launch kernel=gsm_part_kernel grid=(256,1,1) block=(1024,1,1) lds=75520
; @launch kernel=gsm_acc_kernel grid=(256,1,1) block=(1024,1,1) lds=161360
.amdgcn_target "amdgcn-amd-amdhsa--gfx950"
.text
.globl gsm_part_kernel
.p2align 8
.type gsm_part_kernel,@function
gsm_part_kernel:
    s_cmp_ge_u32 s2, 256
    s_cbranch_scc1 gsm_part_kernel_done
    s_load_dwordx4 s[60:63], s[0:1], 8
    s_load_dwordx2 s[64:65], s[0:1], 32
    s_load_dwordx2 s[4:5], s[0:1], 0
    s_load_dwordx2 s[66:67], s[0:1], 72
    s_load_dwordx2 s[68:69], s[0:1], 104
    v_lshlrev_b32 v1, 4, v0
    v_lshlrev_b32 v2, 3, v0
    v_mov_b32 v3, 6
    v_add_u32 v5, 6400, v1
    v_lshrrev_b32 v7, 6, v0
    s_mov_b32 s42, 3435974
    s_mov_b32 s43, 0xfffffb1e
    v_readfirstlane_b32 s56, v7
    s_mov_b32 s44, 40265
    s_lshl_b32 s48, s2, 15
    s_add_u32 s49, s48, 16384
    s_lshl_b32 s50, s2, 14
    s_add_u32 s51, s50, 8192
    s_mul_i32 s52, s2, 53760
    s_mul_i32 s54, s2, 3072
    s_add_u32 s54, s54, 69206016
    s_waitcnt lgkmcnt(0)
    s_mov_b32 s12, s60
    s_and_b32 s13, s61, 0xffff
    s_mov_b32 s14, 40960000
    s_mov_b32 s15, 0x00020000
    s_mov_b32 s16, s62
    s_and_b32 s17, s63, 0xffff
    s_mov_b32 s18, 40960000
    s_mov_b32 s19, 0x00020000
    s_mov_b32 s20, s64
    s_and_b32 s21, s65, 0xffff
    s_mov_b32 s22, 20480000
    s_mov_b32 s23, 0x00020000
    s_and_b32 s3, s2, 1
    s_cmp_eq_u32 s3, 0
    s_movk_i32 s3, 544
    s_cselect_b32 s3, 1024, s3
    v_cmp_gt_u32 vcc, s3, v0
    s_mov_b64 s[36:37], vcc
    buffer_load_dwordx4 v[16:19], v1, s[16:19], s48 offen nt
    buffer_load_dwordx4 v[8:11], v1, s[12:15], s48 offen nt
    buffer_load_dwordx2 v[24:25], v2, s[20:23], s50 offen nt
    buffer_load_dwordx4 v[20:23], v1, s[16:19], s49 offen nt
    buffer_load_dwordx4 v[12:15], v1, s[12:15], s49 offen nt
    buffer_load_dwordx2 v[26:27], v2, s[20:23], s51 offen nt
    s_add_u32 s48, s48, 8388608
    s_add_u32 s49, s49, 8388608
    s_add_u32 s50, s50, 4194304
    s_add_u32 s51, s51, 4194304
    s_mov_b32 s8, s4
    s_and_b32 s9, s5, 0xffff
    s_or_b32 s9, s9, 0x80000
    s_mov_b32 s10, 320000
    s_mov_b32 s11, 0x00020000
    s_mov_b32 s24, s68
    s_and_b32 s25, s69, 0xffff
    s_mov_b32 s26, 268435456
    s_mov_b32 s27, 0x00020000
    s_load_dwordx8 s[76:83], s[66:67], 0
    v_mov_b32 v64, 0
    v_mov_b32 v65, 0
    v_mov_b32 v66, 0
    v_mov_b32 v67, 0
    v_cmp_gt_u32 vcc, 192, v0
    s_mov_b64 exec, vcc
    ds_write_b128 v1, v[64:67] offset:0
    s_mov_b64 exec, -1
    v_add_u32 v70, 60160, v1
    v_cmp_gt_u32 vcc, 960, v0
    s_mov_b64 exec, vcc
    ds_write_b128 v70, v[64:67]
    s_mov_b64 exec, -1
    s_mul_i32 s3, s2, 1250
    v_add_u32 v68, s3, v0
    v_add_u32 v69, 1024, v68
    v_mov_b32 v100, 0
    v_mov_b32 v101, 0
    v_mov_b32 v102, 0
    v_mov_b32 v103, 0
    s_waitcnt lgkmcnt(0)
    s_pack_ll_b32_b16 s28, s76, s78
    s_pack_hh_b32_b16 s29, s76, s78
    s_pack_ll_b32_b16 s30, s77, s79
    s_pack_hh_b32_b16 s31, s77, s79
    s_pack_ll_b32_b16 s32, s80, s82
    s_pack_hh_b32_b16 s33, s80, s82
    s_pack_ll_b32_b16 s34, s81, s83
    s_pack_hh_b32_b16 s35, s81, s83
    s_barrier
    buffer_load_dwordx4 v[36:39], v1, s[16:19], s48 offen nt
    buffer_load_dwordx4 v[28:31], v1, s[12:15], s48 offen nt
    buffer_load_dwordx2 v[44:45], v2, s[20:23], s50 offen nt
    buffer_load_dwordx4 v[40:43], v1, s[16:19], s49 offen nt
    buffer_load_dwordx4 v[32:35], v1, s[12:15], s49 offen nt
    buffer_load_dwordx2 v[46:47], v2, s[20:23], s51 offen nt
    s_add_u32 s48, s48, 8388608
    s_add_u32 s49, s49, 8388608
    s_add_u32 s50, s50, 4194304
    s_add_u32 s51, s51, 4194304
    buffer_load_dwordx2 v[100:101], v68, s[8:11], 0 idxen
    v_cmp_gt_u32 vcc, 226, v0
    s_mov_b64 exec, vcc
    buffer_load_dwordx2 v[102:103], v69, s[8:11], 0 idxen
    s_mov_b64 exec, -1
    s_waitcnt vmcnt(8)
    v_mul_hi_u32_u24 v72, s42, v16
    v_mul_hi_u32_u24 v80, s44, v8
    v_mad_i32_i24 v64, v72, s43, v16
    v_lshlrev_b32 v72, 2, v72
    v_lshl_or_b32 v16, v80, 10, v72
    ds_add_rtn_u32 v48, v16, v3
    v_lshl_or_b32 v56, v64, 19, v8
    v_mul_hi_u32_u24 v73, s42, v17
    v_mul_hi_u32_u24 v81, s44, v9
    v_mad_i32_i24 v65, v73, s43, v17
    v_lshlrev_b32 v73, 2, v73
    v_lshl_or_b32 v17, v81, 10, v73
    ds_add_rtn_u32 v49, v17, v3
    v_lshl_or_b32 v57, v65, 19, v9
    v_mul_hi_u32_u24 v74, s42, v18
    v_mul_hi_u32_u24 v82, s44, v10
    v_mad_i32_i24 v66, v74, s43, v18
    v_lshlrev_b32 v74, 2, v74
    v_lshl_or_b32 v18, v82, 10, v74
    ds_add_rtn_u32 v50, v18, v3
    v_lshl_or_b32 v58, v66, 19, v10
    v_mul_hi_u32_u24 v75, s42, v19
    v_mul_hi_u32_u24 v83, s44, v11
    v_mad_i32_i24 v67, v75, s43, v19
    v_lshlrev_b32 v75, 2, v75
    v_lshl_or_b32 v19, v83, 10, v75
    ds_add_rtn_u32 v51, v19, v3
    v_lshl_or_b32 v59, v67, 19, v11
    v_mul_hi_u32_u24 v76, s42, v20
    v_mul_hi_u32_u24 v84, s44, v12
    v_mad_i32_i24 v68, v76, s43, v20
    v_lshlrev_b32 v76, 2, v76
    v_lshl_or_b32 v20, v84, 10, v76
    ds_add_rtn_u32 v52, v20, v3
    v_lshl_or_b32 v60, v68, 19, v12
    v_mul_hi_u32_u24 v77, s42, v21
    v_mul_hi_u32_u24 v85, s44, v13
    v_mad_i32_i24 v69, v77, s43, v21
    v_lshlrev_b32 v77, 2, v77
    v_lshl_or_b32 v21, v85, 10, v77
    ds_add_rtn_u32 v53, v21, v3
    v_lshl_or_b32 v61, v69, 19, v13
    v_mul_hi_u32_u24 v78, s42, v22
    v_mul_hi_u32_u24 v86, s44, v14
    v_mad_i32_i24 v70, v78, s43, v22
    v_lshlrev_b32 v78, 2, v78
    v_lshl_or_b32 v22, v86, 10, v78
    ds_add_rtn_u32 v54, v22, v3
    v_lshl_or_b32 v62, v70, 19, v14
    v_mul_hi_u32_u24 v79, s42, v23
    v_mul_hi_u32_u24 v87, s44, v15
    v_mad_i32_i24 v71, v79, s43, v23
    v_lshlrev_b32 v79, 2, v79
    v_lshl_or_b32 v23, v87, 10, v79
    ds_add_rtn_u32 v55, v23, v3
    v_lshl_or_b32 v63, v71, 19, v15
    s_waitcnt lgkmcnt(0)
    s_barrier
    s_cmp_lg_u32 s56, 0
    s_cbranch_scc1 L_scanskip_1
    v_mul_u32_u24 v96, 48, v0
    ds_read_b128 v[64:67], v96 offset:0
    ds_read_b128 v[68:71], v96 offset:16
    ds_read_b128 v[72:75], v96 offset:32
    v_mov_b32 v80, 0
    v_mov_b32 v81, 0
    v_mov_b32 v82, 0
    v_mov_b32 v83, 0
    v_mov_b32 v97, 0
    s_waitcnt lgkmcnt(0)
    ds_write_b128 v96, v[80:83] offset:0
    ds_write_b128 v96, v[80:83] offset:16
    ds_write_b128 v96, v[80:83] offset:32
    v_and_b32 v98, 2, v64
    v_mad_u32_u24 v98, v98, 3, v64
    v_add_u32 v97, v97, v98
    v_and_b32 v98, 2, v65
    v_mad_u32_u24 v98, v98, 3, v65
    v_mov_b32 v81, v97
    v_add_u32 v97, v97, v98
    v_and_b32 v98, 2, v66
    v_mad_u32_u24 v98, v98, 3, v66
    v_mov_b32 v82, v97
    v_add_u32 v97, v97, v98
    v_and_b32 v98, 2, v67
    v_mad_u32_u24 v98, v98, 3, v67
    v_mov_b32 v83, v97
    v_add_u32 v97, v97, v98
    v_and_b32 v98, 2, v68
    v_mad_u32_u24 v98, v98, 3, v68
    v_mov_b32 v84, v97
    v_add_u32 v97, v97, v98
    v_and_b32 v98, 2, v69
    v_mad_u32_u24 v98, v98, 3, v69
    v_mov_b32 v85, v97
    v_add_u32 v97, v97, v98
    v_and_b32 v98, 2, v70
    v_mad_u32_u24 v98, v98, 3, v70
    v_mov_b32 v86, v97
    v_add_u32 v97, v97, v98
    v_and_b32 v98, 2, v71
    v_mad_u32_u24 v98, v98, 3, v71
    v_mov_b32 v87, v97
    v_add_u32 v97, v97, v98
    v_and_b32 v98, 2, v72
    v_mad_u32_u24 v98, v98, 3, v72
    v_mov_b32 v88, v97
    v_add_u32 v97, v97, v98
    v_and_b32 v98, 2, v73
    v_mad_u32_u24 v98, v98, 3, v73
    v_mov_b32 v89, v97
    v_add_u32 v97, v97, v98
    v_and_b32 v98, 2, v74
    v_mad_u32_u24 v98, v98, 3, v74
    v_mov_b32 v90, v97
    v_add_u32 v97, v97, v98
    v_and_b32 v98, 2, v75
    v_mad_u32_u24 v98, v98, 3, v75
    v_mov_b32 v91, v97
    v_add_u32 v97, v97, v98
    v_mov_b32 v80, 0
    v_mov_b32 v98, v97
    s_nop 1
    v_add_u32_dpp v98, v98, v98 row_shr:1 row_mask:0xf bank_mask:0xf bound_ctrl:0
    s_nop 1
    v_add_u32_dpp v98, v98, v98 row_shr:2 row_mask:0xf bank_mask:0xf bound_ctrl:0
    s_nop 1
    v_add_u32_dpp v98, v98, v98 row_shr:4 row_mask:0xf bank_mask:0xf bound_ctrl:0
    s_nop 1
    v_add_u32_dpp v98, v98, v98 row_shr:8 row_mask:0xf bank_mask:0xf bound_ctrl:0
    s_nop 1
    v_add_u32_dpp v98, v98, v98 row_bcast:15 row_mask:0xa bank_mask:0xf
    s_nop 1
    v_add_u32_dpp v98, v98, v98 row_bcast:31 row_mask:0xc bank_mask:0xf
    s_nop 1
    v_mov_b32 v99, 6144
    s_mov_b32 exec_lo, 0
    s_mov_b32 exec_hi, 0x80000000
    ds_write_b32 v99, v98
    s_mov_b64 exec, -1
    v_sub_u32 v98, v98, v97
    v_add_u32 v99, 6400, v98
    v_add_u32 v80, v80, v99
    v_add_u32 v81, v81, v99
    v_add_u32 v82, v82, v99
    v_add_u32 v83, v83, v99
    v_add_u32 v84, v84, v99
    v_add_u32 v85, v85, v99
    v_add_u32 v86, v86, v99
    v_add_u32 v87, v87, v99
    v_add_u32 v88, v88, v99
    v_add_u32 v89, v89, v99
    v_add_u32 v90, v90, v99
    v_add_u32 v91, v91, v99
    ds_write_b128 v96, v[80:83] offset:3072
    ds_write_b128 v96, v[84:87] offset:3088
    ds_write_b128 v96, v[88:91] offset:3104
    s_waitcnt lgkmcnt(0)
L_scanskip_1:
    s_barrier
    ds_read_b32 v104, v16 offset:3072
    ds_read_b32 v105, v17 offset:3072
    ds_read_b32 v106, v18 offset:3072
    ds_read_b32 v107, v19 offset:3072
    ds_read_b32 v108, v20 offset:3072
    ds_read_b32 v109, v21 offset:3072
    ds_read_b32 v110, v22 offset:3072
    ds_read_b32 v111, v23 offset:3072
    v_mov_b32 v6, 6144
    ds_read_b32 v6, v6
    s_waitcnt lgkmcnt(8)
    v_add_u32 v104, v104, v48
    v_and_b32 v112, 2, v104
    v_sub_u32 v104, v104, v112
    v_sub_u32 v112, v104, v112
    ds_write_b32 v104, v56
    ds_write_b16 v112, v24 offset:8
    s_waitcnt lgkmcnt(9)
    v_add_u32 v105, v105, v49
    v_and_b32 v113, 2, v105
    v_sub_u32 v105, v105, v113
    v_sub_u32 v113, v105, v113
    ds_write_b32 v105, v57
    ds_write_b16_d16_hi v113, v24 offset:8
    s_waitcnt lgkmcnt(10)
    v_add_u32 v106, v106, v50
    v_and_b32 v114, 2, v106
    v_sub_u32 v106, v106, v114
    v_sub_u32 v114, v106, v114
    ds_write_b32 v106, v58
    ds_write_b16 v114, v25 offset:8
    s_waitcnt lgkmcnt(11)
    v_add_u32 v107, v107, v51
    v_and_b32 v115, 2, v107
    v_sub_u32 v107, v107, v115
    v_sub_u32 v115, v107, v115
    ds_write_b32 v107, v59
    ds_write_b16_d16_hi v115, v25 offset:8
    s_waitcnt lgkmcnt(12)
    v_add_u32 v108, v108, v52
    v_and_b32 v116, 2, v108
    v_sub_u32 v108, v108, v116
    v_sub_u32 v116, v108, v116
    ds_write_b32 v108, v60
    ds_write_b16 v116, v26 offset:8
    s_waitcnt lgkmcnt(13)
    v_add_u32 v109, v109, v53
    v_and_b32 v117, 2, v109
    v_sub_u32 v109, v109, v117
    v_sub_u32 v117, v109, v117
    ds_write_b32 v109, v61
    ds_write_b16_d16_hi v117, v26 offset:8
    s_waitcnt lgkmcnt(14)
    v_add_u32 v110, v110, v54
    v_and_b32 v118, 2, v110
    v_sub_u32 v110, v110, v118
    v_sub_u32 v118, v110, v118
    ds_write_b32 v110, v62
    ds_write_b16 v118, v27 offset:8
    s_waitcnt lgkmcnt(15)
    v_add_u32 v111, v111, v55
    v_and_b32 v119, 2, v111
    v_sub_u32 v111, v111, v119
    v_sub_u32 v119, v111, v119
    ds_write_b32 v111, v63
    ds_write_b16_d16_hi v119, v27 offset:8
    s_cmp_lg_u32 s56, 0
    s_cbranch_scc1 L_dskip_2
    s_mov_b32 s3, 43691
    v_mul_u32_u24 v64, s3, v64
    v_subrev_u32 v80, 6400, v80
    v_mul_u32_u24 v65, s3, v65
    v_subrev_u32 v81, 6400, v81
    v_mul_u32_u24 v66, s3, v66
    v_subrev_u32 v82, 6400, v82
    v_mul_u32_u24 v67, s3, v67
    v_subrev_u32 v83, 6400, v83
    v_mul_u32_u24 v68, s3, v68
    v_subrev_u32 v84, 6400, v84
    v_mul_u32_u24 v69, s3, v69
    v_subrev_u32 v85, 6400, v85
    v_mul_u32_u24 v70, s3, v70
    v_subrev_u32 v86, 6400, v86
    v_mul_u32_u24 v71, s3, v71
    v_subrev_u32 v87, 6400, v87
    v_mul_u32_u24 v72, s3, v72
    v_subrev_u32 v88, 6400, v88
    v_mul_u32_u24 v73, s3, v73
    v_subrev_u32 v89, 6400, v89
    v_mul_u32_u24 v74, s3, v74
    v_subrev_u32 v90, 6400, v90
    v_mul_u32_u24 v75, s3, v75
    v_subrev_u32 v91, 6400, v91
    v_lshrrev_b32 v64, 18, v64
    v_lshrrev_b32 v80, 2, v80
    v_lshrrev_b32 v65, 18, v65
    v_lshrrev_b32 v81, 2, v81
    v_lshrrev_b32 v66, 18, v66
    v_lshrrev_b32 v82, 2, v82
    v_lshrrev_b32 v67, 18, v67
    v_lshrrev_b32 v83, 2, v83
    v_lshrrev_b32 v68, 18, v68
    v_lshrrev_b32 v84, 2, v84
    v_lshrrev_b32 v69, 18, v69
    v_lshrrev_b32 v85, 2, v85
    v_lshrrev_b32 v70, 18, v70
    v_lshrrev_b32 v86, 2, v86
    v_lshrrev_b32 v71, 18, v71
    v_lshrrev_b32 v87, 2, v87
    v_lshrrev_b32 v72, 18, v72
    v_lshrrev_b32 v88, 2, v88
    v_lshrrev_b32 v73, 18, v73
    v_lshrrev_b32 v89, 2, v89
    v_lshrrev_b32 v74, 18, v74
    v_lshrrev_b32 v90, 2, v90
    v_lshrrev_b32 v75, 18, v75
    v_lshrrev_b32 v91, 2, v91
    v_lshl_or_b32 v64, v64, 16, v80
    v_lshl_or_b32 v65, v65, 16, v81
    v_lshl_or_b32 v66, v66, 16, v82
    v_lshl_or_b32 v67, v67, 16, v83
    v_lshl_or_b32 v68, v68, 16, v84
    v_lshl_or_b32 v69, v69, 16, v85
    v_lshl_or_b32 v70, v70, 16, v86
    v_lshl_or_b32 v71, v71, 16, v87
    v_lshl_or_b32 v72, v72, 16, v88
    v_lshl_or_b32 v73, v73, 16, v89
    v_lshl_or_b32 v74, v74, 16, v90
    v_lshl_or_b32 v75, v75, 16, v91
    v_mul_u32_u24 v96, 12, v0
    v_add_u32 v97, 0, v96
    v_and_b32 v98, 255, v97
    v_lshrrev_b32 v97, 8, v97
    v_mad_u32_u24 v98, v98, 15, v97
    v_lshlrev_b32 v80, 2, v98
    v_add_u32 v97, 1, v96
    v_and_b32 v98, 255, v97
    v_lshrrev_b32 v97, 8, v97
    v_mad_u32_u24 v98, v98, 15, v97
    v_lshlrev_b32 v81, 2, v98
    v_add_u32 v97, 2, v96
    v_and_b32 v98, 255, v97
    v_lshrrev_b32 v97, 8, v97
    v_mad_u32_u24 v98, v98, 15, v97
    v_lshlrev_b32 v82, 2, v98
    v_add_u32 v97, 3, v96
    v_and_b32 v98, 255, v97
    v_lshrrev_b32 v97, 8, v97
    v_mad_u32_u24 v98, v98, 15, v97
    v_lshlrev_b32 v83, 2, v98
    v_add_u32 v97, 4, v96
    v_and_b32 v98, 255, v97
    v_lshrrev_b32 v97, 8, v97
    v_mad_u32_u24 v98, v98, 15, v97
    v_lshlrev_b32 v84, 2, v98
    v_add_u32 v97, 5, v96
    v_and_b32 v98, 255, v97
    v_lshrrev_b32 v97, 8, v97
    v_mad_u32_u24 v98, v98, 15, v97
    v_lshlrev_b32 v85, 2, v98
    v_add_u32 v97, 6, v96
    v_and_b32 v98, 255, v97
    v_lshrrev_b32 v97, 8, v97
    v_mad_u32_u24 v98, v98, 15, v97
    v_lshlrev_b32 v86, 2, v98
    v_add_u32 v97, 7, v96
    v_and_b32 v98, 255, v97
    v_lshrrev_b32 v97, 8, v97
    v_mad_u32_u24 v98, v98, 15, v97
    v_lshlrev_b32 v87, 2, v98
    v_add_u32 v97, 8, v96
    v_and_b32 v98, 255, v97
    v_lshrrev_b32 v97, 8, v97
    v_mad_u32_u24 v98, v98, 15, v97
    v_lshlrev_b32 v88, 2, v98
    v_add_u32 v97, 9, v96
    v_and_b32 v98, 255, v97
    v_lshrrev_b32 v97, 8, v97
    v_mad_u32_u24 v98, v98, 15, v97
    v_lshlrev_b32 v89, 2, v98
    v_add_u32 v97, 10, v96
    v_and_b32 v98, 255, v97
    v_lshrrev_b32 v97, 8, v97
    v_mad_u32_u24 v98, v98, 15, v97
    v_lshlrev_b32 v90, 2, v98
    v_add_u32 v97, 11, v96
    v_and_b32 v98, 255, v97
    v_lshrrev_b32 v97, 8, v97
    v_mad_u32_u24 v98, v98, 15, v97
    v_lshlrev_b32 v91, 2, v98
    v_mov_b32 v97, 60160
    v_add_u32 v80, v80, v97
    v_add_u32 v81, v81, v97
    v_add_u32 v82, v82, v97
    v_add_u32 v83, v83, v97
    v_add_u32 v84, v84, v97
    v_add_u32 v85, v85, v97
    v_add_u32 v86, v86, v97
    v_add_u32 v87, v87, v97
    v_add_u32 v88, v88, v97
    v_add_u32 v89, v89, v97
    v_add_u32 v90, v90, v97
    v_add_u32 v91, v91, v97
    ds_write_b32 v80, v64
    ds_write_b32 v81, v65
    ds_write_b32 v82, v66
    ds_write_b32 v83, v67
    ds_write_b32 v84, v68
    ds_write_b32 v85, v69
    ds_write_b32 v86, v70
    ds_write_b32 v87, v71
    ds_write_b32 v88, v72
    ds_write_b32 v89, v73
    ds_write_b32 v90, v74
    ds_write_b32 v91, v75
L_dskip_2:
    s_waitcnt lgkmcnt(0)
    v_subrev_u32 v6, 49152, v6
    v_cmp_gt_i32 vcc, v6, v1
    s_mov_b64 s[38:39], vcc
    s_barrier
    buffer_load_dwordx4 v[16:19], v1, s[16:19], s48 offen nt
    buffer_load_dwordx4 v[8:11], v1, s[12:15], s48 offen nt
    buffer_load_dwordx2 v[24:25], v2, s[20:23], s50 offen nt
    buffer_load_dwordx4 v[20:23], v1, s[16:19], s49 offen nt
    buffer_load_dwordx4 v[12:15], v1, s[12:15], s49 offen nt
    buffer_load_dwordx2 v[26:27], v2, s[20:23], s51 offen nt
    s_add_u32 s48, s48, 8388608
    s_add_u32 s49, s49, 8388608
    s_add_u32 s50, s50, 4194304
    s_add_u32 s51, s51, 4194304
    ds_read_b128 v[48:51], v5 offset:0
    ds_read_b128 v[52:55], v5 offset:16384
    ds_read_b128 v[56:59], v5 offset:32768
    s_mov_b64 exec, s[38:39]
    ds_read_b128 v[60:63], v5 offset:49152
    s_mov_b64 exec, -1
    s_add_u32 s53, s52, 0
    s_waitcnt lgkmcnt(3)
    buffer_store_dwordx4 v[48:51], v1, s[24:27], s53 offen sc1
    s_add_u32 s53, s52, 16384
    s_waitcnt lgkmcnt(2)
    buffer_store_dwordx4 v[52:55], v1, s[24:27], s53 offen sc1
    s_add_u32 s53, s52, 32768
    s_waitcnt lgkmcnt(1)
    buffer_store_dwordx4 v[56:59], v1, s[24:27], s53 offen sc1
    s_add_u32 s53, s52, 49152
    s_mov_b64 exec, s[38:39]
    s_waitcnt lgkmcnt(0)
    buffer_store_dwordx4 v[60:63], v1, s[24:27], s53 offen sc1
    s_mov_b64 exec, -1
    s_add_u32 s52, s52, 13762560
    s_add_u32 s54, s54, 786432
    s_waitcnt vmcnt(10)
    v_mul_hi_u32_u24 v72, s42, v36
    v_mul_hi_u32_u24 v80, s44, v28
    v_mad_i32_i24 v64, v72, s43, v36
    v_lshlrev_b32 v72, 2, v72
    v_lshl_or_b32 v36, v80, 10, v72
    ds_add_rtn_u32 v48, v36, v3
    v_lshl_or_b32 v56, v64, 19, v28
    v_mul_hi_u32_u24 v73, s42, v37
    v_mul_hi_u32_u24 v81, s44, v29
    v_mad_i32_i24 v65, v73, s43, v37
    v_lshlrev_b32 v73, 2, v73
    v_lshl_or_b32 v37, v81, 10, v73
    ds_add_rtn_u32 v49, v37, v3
    v_lshl_or_b32 v57, v65, 19, v29
    v_mul_hi_u32_u24 v74, s42, v38
    v_mul_hi_u32_u24 v82, s44, v30
    v_mad_i32_i24 v66, v74, s43, v38
    v_lshlrev_b32 v74, 2, v74
    v_lshl_or_b32 v38, v82, 10, v74
    ds_add_rtn_u32 v50, v38, v3
    v_lshl_or_b32 v58, v66, 19, v30
    v_mul_hi_u32_u24 v75, s42, v39
    v_mul_hi_u32_u24 v83, s44, v31
    v_mad_i32_i24 v67, v75, s43, v39
    v_lshlrev_b32 v75, 2, v75
    v_lshl_or_b32 v39, v83, 10, v75
    ds_add_rtn_u32 v51, v39, v3
    v_lshl_or_b32 v59, v67, 19, v31
    v_mul_hi_u32_u24 v76, s42, v40
    v_mul_hi_u32_u24 v84, s44, v32
    v_mad_i32_i24 v68, v76, s43, v40
    v_lshlrev_b32 v76, 2, v76
    v_lshl_or_b32 v40, v84, 10, v76
    ds_add_rtn_u32 v52, v40, v3
    v_lshl_or_b32 v60, v68, 19, v32
    v_mul_hi_u32_u24 v77, s42, v41
    v_mul_hi_u32_u24 v85, s44, v33
    v_mad_i32_i24 v69, v77, s43, v41
    v_lshlrev_b32 v77, 2, v77
    v_lshl_or_b32 v41, v85, 10, v77
    ds_add_rtn_u32 v53, v41, v3
    v_lshl_or_b32 v61, v69, 19, v33
    v_mul_hi_u32_u24 v78, s42, v42
    v_mul_hi_u32_u24 v86, s44, v34
    v_mad_i32_i24 v70, v78, s43, v42
    v_lshlrev_b32 v78, 2, v78
    v_lshl_or_b32 v42, v86, 10, v78
    ds_add_rtn_u32 v54, v42, v3
    v_lshl_or_b32 v62, v70, 19, v34
    v_mul_hi_u32_u24 v79, s42, v43
    v_mul_hi_u32_u24 v87, s44, v35
    v_mad_i32_i24 v71, v79, s43, v43
    v_lshlrev_b32 v79, 2, v79
    v_lshl_or_b32 v43, v87, 10, v79
    ds_add_rtn_u32 v55, v43, v3
    v_lshl_or_b32 v63, v71, 19, v35
    s_waitcnt lgkmcnt(0)
    s_barrier
    s_cmp_lg_u32 s56, 0
    s_cbranch_scc1 L_scanskip_3
    v_mul_u32_u24 v96, 48, v0
    ds_read_b128 v[64:67], v96 offset:0
    ds_read_b128 v[68:71], v96 offset:16
    ds_read_b128 v[72:75], v96 offset:32
    v_mov_b32 v80, 0
    v_mov_b32 v81, 0
    v_mov_b32 v82, 0
    v_mov_b32 v83, 0
    v_mov_b32 v97, 0
    s_waitcnt lgkmcnt(0)
    ds_write_b128 v96, v[80:83] offset:0
    ds_write_b128 v96, v[80:83] offset:16
    ds_write_b128 v96, v[80:83] offset:32
    v_and_b32 v98, 2, v64
    v_mad_u32_u24 v98, v98, 3, v64
    v_add_u32 v97, v97, v98
    v_and_b32 v98, 2, v65
    v_mad_u32_u24 v98, v98, 3, v65
    v_mov_b32 v81, v97
    v_add_u32 v97, v97, v98
    v_and_b32 v98, 2, v66
    v_mad_u32_u24 v98, v98, 3, v66
    v_mov_b32 v82, v97
    v_add_u32 v97, v97, v98
    v_and_b32 v98, 2, v67
    v_mad_u32_u24 v98, v98, 3, v67
    v_mov_b32 v83, v97
    v_add_u32 v97, v97, v98
    v_and_b32 v98, 2, v68
    v_mad_u32_u24 v98, v98, 3, v68
    v_mov_b32 v84, v97
    v_add_u32 v97, v97, v98
    v_and_b32 v98, 2, v69
    v_mad_u32_u24 v98, v98, 3, v69
    v_mov_b32 v85, v97
    v_add_u32 v97, v97, v98
    v_and_b32 v98, 2, v70
    v_mad_u32_u24 v98, v98, 3, v70
    v_mov_b32 v86, v97
    v_add_u32 v97, v97, v98
    v_and_b32 v98, 2, v71
    v_mad_u32_u24 v98, v98, 3, v71
    v_mov_b32 v87, v97
    v_add_u32 v97, v97, v98
    v_and_b32 v98, 2, v72
    v_mad_u32_u24 v98, v98, 3, v72
    v_mov_b32 v88, v97
    v_add_u32 v97, v97, v98
    v_and_b32 v98, 2, v73
    v_mad_u32_u24 v98, v98, 3, v73
    v_mov_b32 v89, v97
    v_add_u32 v97, v97, v98
    v_and_b32 v98, 2, v74
    v_mad_u32_u24 v98, v98, 3, v74
    v_mov_b32 v90, v97
    v_add_u32 v97, v97, v98
    v_and_b32 v98, 2, v75
    v_mad_u32_u24 v98, v98, 3, v75
    v_mov_b32 v91, v97
    v_add_u32 v97, v97, v98
    v_mov_b32 v80, 0
    v_mov_b32 v98, v97
    s_nop 1
    v_add_u32_dpp v98, v98, v98 row_shr:1 row_mask:0xf bank_mask:0xf bound_ctrl:0
    s_nop 1
    v_add_u32_dpp v98, v98, v98 row_shr:2 row_mask:0xf bank_mask:0xf bound_ctrl:0
    s_nop 1
    v_add_u32_dpp v98, v98, v98 row_shr:4 row_mask:0xf bank_mask:0xf bound_ctrl:0
    s_nop 1
    v_add_u32_dpp v98, v98, v98 row_shr:8 row_mask:0xf bank_mask:0xf bound_ctrl:0
    s_nop 1
    v_add_u32_dpp v98, v98, v98 row_bcast:15 row_mask:0xa bank_mask:0xf
    s_nop 1
    v_add_u32_dpp v98, v98, v98 row_bcast:31 row_mask:0xc bank_mask:0xf
    s_nop 1
    v_mov_b32 v99, 6144
    s_mov_b32 exec_lo, 0
    s_mov_b32 exec_hi, 0x80000000
    ds_write_b32 v99, v98
    s_mov_b64 exec, -1
    v_sub_u32 v98, v98, v97
    v_add_u32 v99, 6400, v98
    v_add_u32 v80, v80, v99
    v_add_u32 v81, v81, v99
    v_add_u32 v82, v82, v99
    v_add_u32 v83, v83, v99
    v_add_u32 v84, v84, v99
    v_add_u32 v85, v85, v99
    v_add_u32 v86, v86, v99
    v_add_u32 v87, v87, v99
    v_add_u32 v88, v88, v99
    v_add_u32 v89, v89, v99
    v_add_u32 v90, v90, v99
    v_add_u32 v91, v91, v99
    ds_write_b128 v96, v[80:83] offset:3072
    ds_write_b128 v96, v[84:87] offset:3088
    ds_write_b128 v96, v[88:91] offset:3104
    s_waitcnt lgkmcnt(0)
L_scanskip_3:
    s_barrier
    ds_read_b32 v104, v36 offset:3072
    ds_read_b32 v105, v37 offset:3072
    ds_read_b32 v106, v38 offset:3072
    ds_read_b32 v107, v39 offset:3072
    ds_read_b32 v108, v40 offset:3072
    ds_read_b32 v109, v41 offset:3072
    ds_read_b32 v110, v42 offset:3072
    ds_read_b32 v111, v43 offset:3072
    v_mov_b32 v6, 6144
    ds_read_b32 v6, v6
    s_waitcnt lgkmcnt(8)
    v_add_u32 v104, v104, v48
    v_and_b32 v112, 2, v104
    v_sub_u32 v104, v104, v112
    v_sub_u32 v112, v104, v112
    ds_write_b32 v104, v56
    ds_write_b16 v112, v44 offset:8
    s_waitcnt lgkmcnt(9)
    v_add_u32 v105, v105, v49
    v_and_b32 v113, 2, v105
    v_sub_u32 v105, v105, v113
    v_sub_u32 v113, v105, v113
    ds_write_b32 v105, v57
    ds_write_b16_d16_hi v113, v44 offset:8
    s_waitcnt lgkmcnt(10)
    v_add_u32 v106, v106, v50
    v_and_b32 v114, 2, v106
    v_sub_u32 v106, v106, v114
    v_sub_u32 v114, v106, v114
    ds_write_b32 v106, v58
    ds_write_b16 v114, v45 offset:8
    s_waitcnt lgkmcnt(11)
    v_add_u32 v107, v107, v51
    v_and_b32 v115, 2, v107
    v_sub_u32 v107, v107, v115
    v_sub_u32 v115, v107, v115
    ds_write_b32 v107, v59
    ds_write_b16_d16_hi v115, v45 offset:8
    s_waitcnt lgkmcnt(12)
    v_add_u32 v108, v108, v52
    v_and_b32 v116, 2, v108
    v_sub_u32 v108, v108, v116
    v_sub_u32 v116, v108, v116
    ds_write_b32 v108, v60
    ds_write_b16 v116, v46 offset:8
    s_waitcnt lgkmcnt(13)
    v_add_u32 v109, v109, v53
    v_and_b32 v117, 2, v109
    v_sub_u32 v109, v109, v117
    v_sub_u32 v117, v109, v117
    ds_write_b32 v109, v61
    ds_write_b16_d16_hi v117, v46 offset:8
    s_waitcnt lgkmcnt(14)
    v_add_u32 v110, v110, v54
    v_and_b32 v118, 2, v110
    v_sub_u32 v110, v110, v118
    v_sub_u32 v118, v110, v118
    ds_write_b32 v110, v62
    ds_write_b16 v118, v47 offset:8
    s_waitcnt lgkmcnt(15)
    v_add_u32 v111, v111, v55
    v_and_b32 v119, 2, v111
    v_sub_u32 v111, v111, v119
    v_sub_u32 v119, v111, v119
    ds_write_b32 v111, v63
    ds_write_b16_d16_hi v119, v47 offset:8
    s_cmp_lg_u32 s56, 0
    s_cbranch_scc1 L_dskip_4
    s_mov_b32 s3, 43691
    v_mul_u32_u24 v64, s3, v64
    v_subrev_u32 v80, 6400, v80
    v_mul_u32_u24 v65, s3, v65
    v_subrev_u32 v81, 6400, v81
    v_mul_u32_u24 v66, s3, v66
    v_subrev_u32 v82, 6400, v82
    v_mul_u32_u24 v67, s3, v67
    v_subrev_u32 v83, 6400, v83
    v_mul_u32_u24 v68, s3, v68
    v_subrev_u32 v84, 6400, v84
    v_mul_u32_u24 v69, s3, v69
    v_subrev_u32 v85, 6400, v85
    v_mul_u32_u24 v70, s3, v70
    v_subrev_u32 v86, 6400, v86
    v_mul_u32_u24 v71, s3, v71
    v_subrev_u32 v87, 6400, v87
    v_mul_u32_u24 v72, s3, v72
    v_subrev_u32 v88, 6400, v88
    v_mul_u32_u24 v73, s3, v73
    v_subrev_u32 v89, 6400, v89
    v_mul_u32_u24 v74, s3, v74
    v_subrev_u32 v90, 6400, v90
    v_mul_u32_u24 v75, s3, v75
    v_subrev_u32 v91, 6400, v91
    v_lshrrev_b32 v64, 18, v64
    v_lshrrev_b32 v80, 2, v80
    v_lshrrev_b32 v65, 18, v65
    v_lshrrev_b32 v81, 2, v81
    v_lshrrev_b32 v66, 18, v66
    v_lshrrev_b32 v82, 2, v82
    v_lshrrev_b32 v67, 18, v67
    v_lshrrev_b32 v83, 2, v83
    v_lshrrev_b32 v68, 18, v68
    v_lshrrev_b32 v84, 2, v84
    v_lshrrev_b32 v69, 18, v69
    v_lshrrev_b32 v85, 2, v85
    v_lshrrev_b32 v70, 18, v70
    v_lshrrev_b32 v86, 2, v86
    v_lshrrev_b32 v71, 18, v71
    v_lshrrev_b32 v87, 2, v87
    v_lshrrev_b32 v72, 18, v72
    v_lshrrev_b32 v88, 2, v88
    v_lshrrev_b32 v73, 18, v73
    v_lshrrev_b32 v89, 2, v89
    v_lshrrev_b32 v74, 18, v74
    v_lshrrev_b32 v90, 2, v90
    v_lshrrev_b32 v75, 18, v75
    v_lshrrev_b32 v91, 2, v91
    v_lshl_or_b32 v64, v64, 16, v80
    v_lshl_or_b32 v65, v65, 16, v81
    v_lshl_or_b32 v66, v66, 16, v82
    v_lshl_or_b32 v67, v67, 16, v83
    v_lshl_or_b32 v68, v68, 16, v84
    v_lshl_or_b32 v69, v69, 16, v85
    v_lshl_or_b32 v70, v70, 16, v86
    v_lshl_or_b32 v71, v71, 16, v87
    v_lshl_or_b32 v72, v72, 16, v88
    v_lshl_or_b32 v73, v73, 16, v89
    v_lshl_or_b32 v74, v74, 16, v90
    v_lshl_or_b32 v75, v75, 16, v91
    v_mul_u32_u24 v96, 12, v0
    v_add_u32 v97, 0, v96
    v_and_b32 v98, 255, v97
    v_lshrrev_b32 v97, 8, v97
    v_mad_u32_u24 v98, v98, 15, v97
    v_lshlrev_b32 v80, 2, v98
    v_add_u32 v97, 1, v96
    v_and_b32 v98, 255, v97
    v_lshrrev_b32 v97, 8, v97
    v_mad_u32_u24 v98, v98, 15, v97
    v_lshlrev_b32 v81, 2, v98
    v_add_u32 v97, 2, v96
    v_and_b32 v98, 255, v97
    v_lshrrev_b32 v97, 8, v97
    v_mad_u32_u24 v98, v98, 15, v97
    v_lshlrev_b32 v82, 2, v98
    v_add_u32 v97, 3, v96
    v_and_b32 v98, 255, v97
    v_lshrrev_b32 v97, 8, v97
    v_mad_u32_u24 v98, v98, 15, v97
    v_lshlrev_b32 v83, 2, v98
    v_add_u32 v97, 4, v96
    v_and_b32 v98, 255, v97
    v_lshrrev_b32 v97, 8, v97
    v_mad_u32_u24 v98, v98, 15, v97
    v_lshlrev_b32 v84, 2, v98
    v_add_u32 v97, 5, v96
    v_and_b32 v98, 255, v97
    v_lshrrev_b32 v97, 8, v97
    v_mad_u32_u24 v98, v98, 15, v97
    v_lshlrev_b32 v85, 2, v98
    v_add_u32 v97, 6, v96
    v_and_b32 v98, 255, v97
    v_lshrrev_b32 v97, 8, v97
    v_mad_u32_u24 v98, v98, 15, v97
    v_lshlrev_b32 v86, 2, v98
    v_add_u32 v97, 7, v96
    v_and_b32 v98, 255, v97
    v_lshrrev_b32 v97, 8, v97
    v_mad_u32_u24 v98, v98, 15, v97
    v_lshlrev_b32 v87, 2, v98
    v_add_u32 v97, 8, v96
    v_and_b32 v98, 255, v97
    v_lshrrev_b32 v97, 8, v97
    v_mad_u32_u24 v98, v98, 15, v97
    v_lshlrev_b32 v88, 2, v98
    v_add_u32 v97, 9, v96
    v_and_b32 v98, 255, v97
    v_lshrrev_b32 v97, 8, v97
    v_mad_u32_u24 v98, v98, 15, v97
    v_lshlrev_b32 v89, 2, v98
    v_add_u32 v97, 10, v96
    v_and_b32 v98, 255, v97
    v_lshrrev_b32 v97, 8, v97
    v_mad_u32_u24 v98, v98, 15, v97
    v_lshlrev_b32 v90, 2, v98
    v_add_u32 v97, 11, v96
    v_and_b32 v98, 255, v97
    v_lshrrev_b32 v97, 8, v97
    v_mad_u32_u24 v98, v98, 15, v97
    v_lshlrev_b32 v91, 2, v98
    v_mov_b32 v97, 60172
    v_add_u32 v80, v80, v97
    v_add_u32 v81, v81, v97
    v_add_u32 v82, v82, v97
    v_add_u32 v83, v83, v97
    v_add_u32 v84, v84, v97
    v_add_u32 v85, v85, v97
    v_add_u32 v86, v86, v97
    v_add_u32 v87, v87, v97
    v_add_u32 v88, v88, v97
    v_add_u32 v89, v89, v97
    v_add_u32 v90, v90, v97
    v_add_u32 v91, v91, v97
    ds_write_b32 v80, v64
    ds_write_b32 v81, v65
    ds_write_b32 v82, v66
    ds_write_b32 v83, v67
    ds_write_b32 v84, v68
    ds_write_b32 v85, v69
    ds_write_b32 v86, v70
    ds_write_b32 v87, v71
    ds_write_b32 v88, v72
    ds_write_b32 v89, v73
    ds_write_b32 v90, v74
    ds_write_b32 v91, v75
L_dskip_4:
    v_dot2_f32_bf16 v80, v100, s28, 0
    v_dot2_f32_bf16 v81, v100, s29, 0
    v_dot2_f32_bf16 v82, v100, s30, 0
    v_dot2_f32_bf16 v83, v100, s31, 0
    v_dot2_f32_bf16 v80, v101, s32, v80
    v_dot2_f32_bf16 v81, v101, s33, v81
    v_dot2_f32_bf16 v82, v101, s34, v82
    v_dot2_f32_bf16 v83, v101, s35, v83
    v_dot2_f32_bf16 v84, v102, s28, 0
    v_dot2_f32_bf16 v85, v102, s29, 0
    v_dot2_f32_bf16 v86, v102, s30, 0
    v_dot2_f32_bf16 v87, v102, s31, 0
    v_dot2_f32_bf16 v84, v103, s32, v84
    v_dot2_f32_bf16 v85, v103, s33, v85
    v_dot2_f32_bf16 v86, v103, s34, v86
    v_dot2_f32_bf16 v87, v103, s35, v87
    s_nop 2
    v_cvt_pk_bf16_f32 v100, v80, v81
    v_cvt_pk_bf16_f32 v101, v82, v83
    v_cvt_pk_bf16_f32 v102, v84, v85
    v_cvt_pk_bf16_f32 v103, v86, v87
    s_mul_i32 s3, s2, 10000
    s_add_u32 s3, s3, 83394560
    buffer_store_dwordx2 v[100:101], v2, s[24:27], s3 offen
    v_cmp_gt_u32 vcc, 226, v0
    s_add_u32 s3, s3, 8192
    s_mov_b64 exec, vcc
    buffer_store_dwordx2 v[102:103], v2, s[24:27], s3 offen
    s_mov_b64 exec, -1
    v_max3_f32 v88, |v80|, |v81|, |v82|
    v_max3_f32 v89, |v83|, |v84|, |v85|
    v_max3_f32 v88, |v86|, |v87|, v88
    v_max_f32 v88, v88, v89
    s_nop 1
    v_max_u32_dpp v88, v88, v88 row_shr:1 row_mask:0xf bank_mask:0xf
    s_nop 1
    v_max_u32_dpp v88, v88, v88 row_shr:2 row_mask:0xf bank_mask:0xf
    s_nop 1
    v_max_u32_dpp v88, v88, v88 row_shr:4 row_mask:0xf bank_mask:0xf
    s_nop 1
    v_max_u32_dpp v88, v88, v88 row_shr:8 row_mask:0xf bank_mask:0xf
    s_nop 1
    v_max_u32_dpp v88, v88, v88 row_bcast:15 row_mask:0xa bank_mask:0xf
    s_nop 1
    v_max_u32_dpp v88, v88, v88 row_bcast:31 row_mask:0xc bank_mask:0xf
    s_nop 1
    s_lshl_b32 s3, s2, 4
    s_add_u32 s3, s3, s56
    s_lshl_b32 s3, s3, 2
    s_add_u32 s3, s3, 73138176
    v_mov_b32 v89, 0
    s_mov_b32 exec_lo, 0
    s_mov_b32 exec_hi, 0x80000000
    buffer_store_dword v88, v89, s[24:27], s3 offen
    s_mov_b64 exec, -1
    s_waitcnt lgkmcnt(0)
    v_subrev_u32 v6, 49152, v6
    v_cmp_gt_i32 vcc, v6, v1
    s_mov_b64 s[38:39], vcc
    s_barrier
    buffer_load_dwordx4 v[36:39], v1, s[16:19], s48 offen nt
    buffer_load_dwordx4 v[28:31], v1, s[12:15], s48 offen nt
    buffer_load_dwordx2 v[44:45], v2, s[20:23], s50 offen nt
    buffer_load_dwordx4 v[40:43], v1, s[16:19], s49 offen nt
    buffer_load_dwordx4 v[32:35], v1, s[12:15], s49 offen nt
    buffer_load_dwordx2 v[46:47], v2, s[20:23], s51 offen nt
    s_add_u32 s48, s48, 8388608
    s_add_u32 s49, s49, 8388608
    s_add_u32 s50, s50, 4194304
    s_add_u32 s51, s51, 4194304
    ds_read_b128 v[48:51], v5 offset:0
    ds_read_b128 v[52:55], v5 offset:16384
    ds_read_b128 v[56:59], v5 offset:32768
    s_mov_b64 exec, s[38:39]
    ds_read_b128 v[60:63], v5 offset:49152
    s_mov_b64 exec, -1
    s_add_u32 s53, s52, 0
    s_waitcnt lgkmcnt(3)
    buffer_store_dwordx4 v[48:51], v1, s[24:27], s53 offen sc1
    s_add_u32 s53, s52, 16384
    s_waitcnt lgkmcnt(2)
    buffer_store_dwordx4 v[52:55], v1, s[24:27], s53 offen sc1
    s_add_u32 s53, s52, 32768
    s_waitcnt lgkmcnt(1)
    buffer_store_dwordx4 v[56:59], v1, s[24:27], s53 offen sc1
    s_add_u32 s53, s52, 49152
    s_mov_b64 exec, s[38:39]
    s_waitcnt lgkmcnt(0)
    buffer_store_dwordx4 v[60:63], v1, s[24:27], s53 offen sc1
    s_mov_b64 exec, -1
    s_add_u32 s52, s52, 13762560
    s_add_u32 s54, s54, 786432
    s_waitcnt vmcnt(10)
    v_mul_hi_u32_u24 v72, s42, v16
    v_mul_hi_u32_u24 v80, s44, v8
    v_mad_i32_i24 v64, v72, s43, v16
    v_lshlrev_b32 v72, 2, v72
    v_lshl_or_b32 v16, v80, 10, v72
    ds_add_rtn_u32 v48, v16, v3
    v_lshl_or_b32 v56, v64, 19, v8
    v_mul_hi_u32_u24 v73, s42, v17
    v_mul_hi_u32_u24 v81, s44, v9
    v_mad_i32_i24 v65, v73, s43, v17
    v_lshlrev_b32 v73, 2, v73
    v_lshl_or_b32 v17, v81, 10, v73
    ds_add_rtn_u32 v49, v17, v3
    v_lshl_or_b32 v57, v65, 19, v9
    v_mul_hi_u32_u24 v74, s42, v18
    v_mul_hi_u32_u24 v82, s44, v10
    v_mad_i32_i24 v66, v74, s43, v18
    v_lshlrev_b32 v74, 2, v74
    v_lshl_or_b32 v18, v82, 10, v74
    ds_add_rtn_u32 v50, v18, v3
    v_lshl_or_b32 v58, v66, 19, v10
    v_mul_hi_u32_u24 v75, s42, v19
    v_mul_hi_u32_u24 v83, s44, v11
    v_mad_i32_i24 v67, v75, s43, v19
    v_lshlrev_b32 v75, 2, v75
    v_lshl_or_b32 v19, v83, 10, v75
    ds_add_rtn_u32 v51, v19, v3
    v_lshl_or_b32 v59, v67, 19, v11
    v_mul_hi_u32_u24 v76, s42, v20
    v_mul_hi_u32_u24 v84, s44, v12
    v_mad_i32_i24 v68, v76, s43, v20
    v_lshlrev_b32 v76, 2, v76
    v_lshl_or_b32 v20, v84, 10, v76
    ds_add_rtn_u32 v52, v20, v3
    v_lshl_or_b32 v60, v68, 19, v12
    v_mul_hi_u32_u24 v77, s42, v21
    v_mul_hi_u32_u24 v85, s44, v13
    v_mad_i32_i24 v69, v77, s43, v21
    v_lshlrev_b32 v77, 2, v77
    v_lshl_or_b32 v21, v85, 10, v77
    ds_add_rtn_u32 v53, v21, v3
    v_lshl_or_b32 v61, v69, 19, v13
    v_mul_hi_u32_u24 v78, s42, v22
    v_mul_hi_u32_u24 v86, s44, v14
    v_mad_i32_i24 v70, v78, s43, v22
    v_lshlrev_b32 v78, 2, v78
    v_lshl_or_b32 v22, v86, 10, v78
    ds_add_rtn_u32 v54, v22, v3
    v_lshl_or_b32 v62, v70, 19, v14
    v_mul_hi_u32_u24 v79, s42, v23
    v_mul_hi_u32_u24 v87, s44, v15
    v_mad_i32_i24 v71, v79, s43, v23
    v_lshlrev_b32 v79, 2, v79
    v_lshl_or_b32 v23, v87, 10, v79
    ds_add_rtn_u32 v55, v23, v3
    v_lshl_or_b32 v63, v71, 19, v15
    s_waitcnt lgkmcnt(0)
    s_barrier
    s_cmp_lg_u32 s56, 0
    s_cbranch_scc1 L_scanskip_5
    v_mul_u32_u24 v96, 48, v0
    ds_read_b128 v[64:67], v96 offset:0
    ds_read_b128 v[68:71], v96 offset:16
    ds_read_b128 v[72:75], v96 offset:32
    v_mov_b32 v80, 0
    v_mov_b32 v81, 0
    v_mov_b32 v82, 0
    v_mov_b32 v83, 0
    v_mov_b32 v97, 0
    s_waitcnt lgkmcnt(0)
    ds_write_b128 v96, v[80:83] offset:0
    ds_write_b128 v96, v[80:83] offset:16
    ds_write_b128 v96, v[80:83] offset:32
    v_and_b32 v98, 2, v64
    v_mad_u32_u24 v98, v98, 3, v64
    v_add_u32 v97, v97, v98
    v_and_b32 v98, 2, v65
    v_mad_u32_u24 v98, v98, 3, v65
    v_mov_b32 v81, v97
    v_add_u32 v97, v97, v98
    v_and_b32 v98, 2, v66
    v_mad_u32_u24 v98, v98, 3, v66
    v_mov_b32 v82, v97
    v_add_u32 v97, v97, v98
    v_and_b32 v98, 2, v67
    v_mad_u32_u24 v98, v98, 3, v67
    v_mov_b32 v83, v97
    v_add_u32 v97, v97, v98
    v_and_b32 v98, 2, v68
    v_mad_u32_u24 v98, v98, 3, v68
    v_mov_b32 v84, v97
    v_add_u32 v97, v97, v98
    v_and_b32 v98, 2, v69
    v_mad_u32_u24 v98, v98, 3, v69
    v_mov_b32 v85, v97
    v_add_u32 v97, v97, v98
    v_and_b32 v98, 2, v70
    v_mad_u32_u24 v98, v98, 3, v70
    v_mov_b32 v86, v97
    v_add_u32 v97, v97, v98
    v_and_b32 v98, 2, v71
    v_mad_u32_u24 v98, v98, 3, v71
    v_mov_b32 v87, v97
    v_add_u32 v97, v97, v98
    v_and_b32 v98, 2, v72
    v_mad_u32_u24 v98, v98, 3, v72
    v_mov_b32 v88, v97
    v_add_u32 v97, v97, v98
    v_and_b32 v98, 2, v73
    v_mad_u32_u24 v98, v98, 3, v73
    v_mov_b32 v89, v97
    v_add_u32 v97, v97, v98
    v_and_b32 v98, 2, v74
    v_mad_u32_u24 v98, v98, 3, v74
    v_mov_b32 v90, v97
    v_add_u32 v97, v97, v98
    v_and_b32 v98, 2, v75
    v_mad_u32_u24 v98, v98, 3, v75
    v_mov_b32 v91, v97
    v_add_u32 v97, v97, v98
    v_mov_b32 v80, 0
    v_mov_b32 v98, v97
    s_nop 1
    v_add_u32_dpp v98, v98, v98 row_shr:1 row_mask:0xf bank_mask:0xf bound_ctrl:0
    s_nop 1
    v_add_u32_dpp v98, v98, v98 row_shr:2 row_mask:0xf bank_mask:0xf bound_ctrl:0
    s_nop 1
    v_add_u32_dpp v98, v98, v98 row_shr:4 row_mask:0xf bank_mask:0xf bound_ctrl:0
    s_nop 1
    v_add_u32_dpp v98, v98, v98 row_shr:8 row_mask:0xf bank_mask:0xf bound_ctrl:0
    s_nop 1
    v_add_u32_dpp v98, v98, v98 row_bcast:15 row_mask:0xa bank_mask:0xf
    s_nop 1
    v_add_u32_dpp v98, v98, v98 row_bcast:31 row_mask:0xc bank_mask:0xf
    s_nop 1
    v_mov_b32 v99, 6144
    s_mov_b32 exec_lo, 0
    s_mov_b32 exec_hi, 0x80000000
    ds_write_b32 v99, v98
    s_mov_b64 exec, -1
    v_sub_u32 v98, v98, v97
    v_add_u32 v99, 6400, v98
    v_add_u32 v80, v80, v99
    v_add_u32 v81, v81, v99
    v_add_u32 v82, v82, v99
    v_add_u32 v83, v83, v99
    v_add_u32 v84, v84, v99
    v_add_u32 v85, v85, v99
    v_add_u32 v86, v86, v99
    v_add_u32 v87, v87, v99
    v_add_u32 v88, v88, v99
    v_add_u32 v89, v89, v99
    v_add_u32 v90, v90, v99
    v_add_u32 v91, v91, v99
    ds_write_b128 v96, v[80:83] offset:3072
    ds_write_b128 v96, v[84:87] offset:3088
    ds_write_b128 v96, v[88:91] offset:3104
    s_waitcnt lgkmcnt(0)
L_scanskip_5:
    s_barrier
    ds_read_b32 v104, v16 offset:3072
    ds_read_b32 v105, v17 offset:3072
    ds_read_b32 v106, v18 offset:3072
    ds_read_b32 v107, v19 offset:3072
    ds_read_b32 v108, v20 offset:3072
    ds_read_b32 v109, v21 offset:3072
    ds_read_b32 v110, v22 offset:3072
    ds_read_b32 v111, v23 offset:3072
    v_mov_b32 v6, 6144
    ds_read_b32 v6, v6
    s_waitcnt lgkmcnt(8)
    v_add_u32 v104, v104, v48
    v_and_b32 v112, 2, v104
    v_sub_u32 v104, v104, v112
    v_sub_u32 v112, v104, v112
    ds_write_b32 v104, v56
    ds_write_b16 v112, v24 offset:8
    s_waitcnt lgkmcnt(9)
    v_add_u32 v105, v105, v49
    v_and_b32 v113, 2, v105
    v_sub_u32 v105, v105, v113
    v_sub_u32 v113, v105, v113
    ds_write_b32 v105, v57
    ds_write_b16_d16_hi v113, v24 offset:8
    s_waitcnt lgkmcnt(10)
    v_add_u32 v106, v106, v50
    v_and_b32 v114, 2, v106
    v_sub_u32 v106, v106, v114
    v_sub_u32 v114, v106, v114
    ds_write_b32 v106, v58
    ds_write_b16 v114, v25 offset:8
    s_waitcnt lgkmcnt(11)
    v_add_u32 v107, v107, v51
    v_and_b32 v115, 2, v107
    v_sub_u32 v107, v107, v115
    v_sub_u32 v115, v107, v115
    ds_write_b32 v107, v59
    ds_write_b16_d16_hi v115, v25 offset:8
    s_waitcnt lgkmcnt(12)
    v_add_u32 v108, v108, v52
    v_and_b32 v116, 2, v108
    v_sub_u32 v108, v108, v116
    v_sub_u32 v116, v108, v116
    ds_write_b32 v108, v60
    ds_write_b16 v116, v26 offset:8
    s_waitcnt lgkmcnt(13)
    v_add_u32 v109, v109, v53
    v_and_b32 v117, 2, v109
    v_sub_u32 v109, v109, v117
    v_sub_u32 v117, v109, v117
    ds_write_b32 v109, v61
    ds_write_b16_d16_hi v117, v26 offset:8
    s_waitcnt lgkmcnt(14)
    v_add_u32 v110, v110, v54
    v_and_b32 v118, 2, v110
    v_sub_u32 v110, v110, v118
    v_sub_u32 v118, v110, v118
    ds_write_b32 v110, v62
    ds_write_b16 v118, v27 offset:8
    s_waitcnt lgkmcnt(15)
    v_add_u32 v111, v111, v55
    v_and_b32 v119, 2, v111
    v_sub_u32 v111, v111, v119
    v_sub_u32 v119, v111, v119
    ds_write_b32 v111, v63
    ds_write_b16_d16_hi v119, v27 offset:8
    s_cmp_lg_u32 s56, 0
    s_cbranch_scc1 L_dskip_6
    s_mov_b32 s3, 43691
    v_mul_u32_u24 v64, s3, v64
    v_subrev_u32 v80, 6400, v80
    v_mul_u32_u24 v65, s3, v65
    v_subrev_u32 v81, 6400, v81
    v_mul_u32_u24 v66, s3, v66
    v_subrev_u32 v82, 6400, v82
    v_mul_u32_u24 v67, s3, v67
    v_subrev_u32 v83, 6400, v83
    v_mul_u32_u24 v68, s3, v68
    v_subrev_u32 v84, 6400, v84
    v_mul_u32_u24 v69, s3, v69
    v_subrev_u32 v85, 6400, v85
    v_mul_u32_u24 v70, s3, v70
    v_subrev_u32 v86, 6400, v86
    v_mul_u32_u24 v71, s3, v71
    v_subrev_u32 v87, 6400, v87
    v_mul_u32_u24 v72, s3, v72
    v_subrev_u32 v88, 6400, v88
    v_mul_u32_u24 v73, s3, v73
    v_subrev_u32 v89, 6400, v89
    v_mul_u32_u24 v74, s3, v74
    v_subrev_u32 v90, 6400, v90
    v_mul_u32_u24 v75, s3, v75
    v_subrev_u32 v91, 6400, v91
    v_lshrrev_b32 v64, 18, v64
    v_lshrrev_b32 v80, 2, v80
    v_lshrrev_b32 v65, 18, v65
    v_lshrrev_b32 v81, 2, v81
    v_lshrrev_b32 v66, 18, v66
    v_lshrrev_b32 v82, 2, v82
    v_lshrrev_b32 v67, 18, v67
    v_lshrrev_b32 v83, 2, v83
    v_lshrrev_b32 v68, 18, v68
    v_lshrrev_b32 v84, 2, v84
    v_lshrrev_b32 v69, 18, v69
    v_lshrrev_b32 v85, 2, v85
    v_lshrrev_b32 v70, 18, v70
    v_lshrrev_b32 v86, 2, v86
    v_lshrrev_b32 v71, 18, v71
    v_lshrrev_b32 v87, 2, v87
    v_lshrrev_b32 v72, 18, v72
    v_lshrrev_b32 v88, 2, v88
    v_lshrrev_b32 v73, 18, v73
    v_lshrrev_b32 v89, 2, v89
    v_lshrrev_b32 v74, 18, v74
    v_lshrrev_b32 v90, 2, v90
    v_lshrrev_b32 v75, 18, v75
    v_lshrrev_b32 v91, 2, v91
    v_lshl_or_b32 v64, v64, 16, v80
    v_lshl_or_b32 v65, v65, 16, v81
    v_lshl_or_b32 v66, v66, 16, v82
    v_lshl_or_b32 v67, v67, 16, v83
    v_lshl_or_b32 v68, v68, 16, v84
    v_lshl_or_b32 v69, v69, 16, v85
    v_lshl_or_b32 v70, v70, 16, v86
    v_lshl_or_b32 v71, v71, 16, v87
    v_lshl_or_b32 v72, v72, 16, v88
    v_lshl_or_b32 v73, v73, 16, v89
    v_lshl_or_b32 v74, v74, 16, v90
    v_lshl_or_b32 v75, v75, 16, v91
    v_mul_u32_u24 v96, 12, v0
    v_add_u32 v97, 0, v96
    v_and_b32 v98, 255, v97
    v_lshrrev_b32 v97, 8, v97
    v_mad_u32_u24 v98, v98, 15, v97
    v_lshlrev_b32 v80, 2, v98
    v_add_u32 v97, 1, v96
    v_and_b32 v98, 255, v97
    v_lshrrev_b32 v97, 8, v97
    v_mad_u32_u24 v98, v98, 15, v97
    v_lshlrev_b32 v81, 2, v98
    v_add_u32 v97, 2, v96
    v_and_b32 v98, 255, v97
    v_lshrrev_b32 v97, 8, v97
    v_mad_u32_u24 v98, v98, 15, v97
    v_lshlrev_b32 v82, 2, v98
    v_add_u32 v97, 3, v96
    v_and_b32 v98, 255, v97
    v_lshrrev_b32 v97, 8, v97
    v_mad_u32_u24 v98, v98, 15, v97
    v_lshlrev_b32 v83, 2, v98
    v_add_u32 v97, 4, v96
    v_and_b32 v98, 255, v97
    v_lshrrev_b32 v97, 8, v97
    v_mad_u32_u24 v98, v98, 15, v97
    v_lshlrev_b32 v84, 2, v98
    v_add_u32 v97, 5, v96
    v_and_b32 v98, 255, v97
    v_lshrrev_b32 v97, 8, v97
    v_mad_u32_u24 v98, v98, 15, v97
    v_lshlrev_b32 v85, 2, v98
    v_add_u32 v97, 6, v96
    v_and_b32 v98, 255, v97
    v_lshrrev_b32 v97, 8, v97
    v_mad_u32_u24 v98, v98, 15, v97
    v_lshlrev_b32 v86, 2, v98
    v_add_u32 v97, 7, v96
    v_and_b32 v98, 255, v97
    v_lshrrev_b32 v97, 8, v97
    v_mad_u32_u24 v98, v98, 15, v97
    v_lshlrev_b32 v87, 2, v98
    v_add_u32 v97, 8, v96
    v_and_b32 v98, 255, v97
    v_lshrrev_b32 v97, 8, v97
    v_mad_u32_u24 v98, v98, 15, v97
    v_lshlrev_b32 v88, 2, v98
    v_add_u32 v97, 9, v96
    v_and_b32 v98, 255, v97
    v_lshrrev_b32 v97, 8, v97
    v_mad_u32_u24 v98, v98, 15, v97
    v_lshlrev_b32 v89, 2, v98
    v_add_u32 v97, 10, v96
    v_and_b32 v98, 255, v97
    v_lshrrev_b32 v97, 8, v97
    v_mad_u32_u24 v98, v98, 15, v97
    v_lshlrev_b32 v90, 2, v98
    v_add_u32 v97, 11, v96
    v_and_b32 v98, 255, v97
    v_lshrrev_b32 v97, 8, v97
    v_mad_u32_u24 v98, v98, 15, v97
    v_lshlrev_b32 v91, 2, v98
    v_mov_b32 v97, 60184
    v_add_u32 v80, v80, v97
    v_add_u32 v81, v81, v97
    v_add_u32 v82, v82, v97
    v_add_u32 v83, v83, v97
    v_add_u32 v84, v84, v97
    v_add_u32 v85, v85, v97
    v_add_u32 v86, v86, v97
    v_add_u32 v87, v87, v97
    v_add_u32 v88, v88, v97
    v_add_u32 v89, v89, v97
    v_add_u32 v90, v90, v97
    v_add_u32 v91, v91, v97
    ds_write_b32 v80, v64
    ds_write_b32 v81, v65
    ds_write_b32 v82, v66
    ds_write_b32 v83, v67
    ds_write_b32 v84, v68
    ds_write_b32 v85, v69
    ds_write_b32 v86, v70
    ds_write_b32 v87, v71
    ds_write_b32 v88, v72
    ds_write_b32 v89, v73
    ds_write_b32 v90, v74
    ds_write_b32 v91, v75
L_dskip_6:
    s_waitcnt lgkmcnt(0)
    v_subrev_u32 v6, 49152, v6
    v_cmp_gt_i32 vcc, v6, v1
    s_mov_b64 s[38:39], vcc
    s_barrier
    s_lshr_b32 s3, s2, 1
    s_mul_i32 s3, s3, 14464
    s_and_b32 s48, s2, 1
    s_lshl_b32 s48, s48, 13
    s_add_u32 s3, s3, s48
    s_add_u32 s3, s3, 8388608
    s_lshl_b32 s48, s3, 2
    s_add_u32 s49, s48, 16384
    s_lshl_b32 s50, s3, 1
    s_add_u32 s51, s50, 8192
    buffer_load_dwordx4 v[16:19], v1, s[16:19], s48 offen nt
    buffer_load_dwordx4 v[8:11], v1, s[12:15], s48 offen nt
    buffer_load_dwordx2 v[24:25], v2, s[20:23], s50 offen nt
    s_mov_b64 exec, s[36:37]
    buffer_load_dwordx4 v[20:23], v1, s[16:19], s49 offen nt
    buffer_load_dwordx4 v[12:15], v1, s[12:15], s49 offen nt
    buffer_load_dwordx2 v[26:27], v2, s[20:23], s51 offen nt
    s_mov_b64 exec, -1
    s_add_u32 s48, s48, 8388608
    s_add_u32 s49, s49, 8388608
    s_add_u32 s50, s50, 4194304
    s_add_u32 s51, s51, 4194304
    ds_read_b128 v[48:51], v5 offset:0
    ds_read_b128 v[52:55], v5 offset:16384
    ds_read_b128 v[56:59], v5 offset:32768
    s_mov_b64 exec, s[38:39]
    ds_read_b128 v[60:63], v5 offset:49152
    s_mov_b64 exec, -1
    s_add_u32 s53, s52, 0
    s_waitcnt lgkmcnt(3)
    buffer_store_dwordx4 v[48:51], v1, s[24:27], s53 offen sc1
    s_add_u32 s53, s52, 16384
    s_waitcnt lgkmcnt(2)
    buffer_store_dwordx4 v[52:55], v1, s[24:27], s53 offen sc1
    s_add_u32 s53, s52, 32768
    s_waitcnt lgkmcnt(1)
    buffer_store_dwordx4 v[56:59], v1, s[24:27], s53 offen sc1
    s_add_u32 s53, s52, 49152
    s_mov_b64 exec, s[38:39]
    s_waitcnt lgkmcnt(0)
    buffer_store_dwordx4 v[60:63], v1, s[24:27], s53 offen sc1
    s_mov_b64 exec, -1
    s_add_u32 s52, s52, 13762560
    s_add_u32 s54, s54, 786432
    s_waitcnt vmcnt(10)
    v_mul_hi_u32_u24 v72, s42, v36
    v_mul_hi_u32_u24 v80, s44, v28
    v_mad_i32_i24 v64, v72, s43, v36
    v_lshlrev_b32 v72, 2, v72
    v_lshl_or_b32 v36, v80, 10, v72
    ds_add_rtn_u32 v48, v36, v3
    v_lshl_or_b32 v56, v64, 19, v28
    v_mul_hi_u32_u24 v73, s42, v37
    v_mul_hi_u32_u24 v81, s44, v29
    v_mad_i32_i24 v65, v73, s43, v37
    v_lshlrev_b32 v73, 2, v73
    v_lshl_or_b32 v37, v81, 10, v73
    ds_add_rtn_u32 v49, v37, v3
    v_lshl_or_b32 v57, v65, 19, v29
    v_mul_hi_u32_u24 v74, s42, v38
    v_mul_hi_u32_u24 v82, s44, v30
    v_mad_i32_i24 v66, v74, s43, v38
    v_lshlrev_b32 v74, 2, v74
    v_lshl_or_b32 v38, v82, 10, v74
    ds_add_rtn_u32 v50, v38, v3
    v_lshl_or_b32 v58, v66, 19, v30
    v_mul_hi_u32_u24 v75, s42, v39
    v_mul_hi_u32_u24 v83, s44, v31
    v_mad_i32_i24 v67, v75, s43, v39
    v_lshlrev_b32 v75, 2, v75
    v_lshl_or_b32 v39, v83, 10, v75
    ds_add_rtn_u32 v51, v39, v3
    v_lshl_or_b32 v59, v67, 19, v31
    v_mul_hi_u32_u24 v76, s42, v40
    v_mul_hi_u32_u24 v84, s44, v32
    v_mad_i32_i24 v68, v76, s43, v40
    v_lshlrev_b32 v76, 2, v76
    v_lshl_or_b32 v40, v84, 10, v76
    ds_add_rtn_u32 v52, v40, v3
    v_lshl_or_b32 v60, v68, 19, v32
    v_mul_hi_u32_u24 v77, s42, v41
    v_mul_hi_u32_u24 v85, s44, v33
    v_mad_i32_i24 v69, v77, s43, v41
    v_lshlrev_b32 v77, 2, v77
    v_lshl_or_b32 v41, v85, 10, v77
    ds_add_rtn_u32 v53, v41, v3
    v_lshl_or_b32 v61, v69, 19, v33
    v_mul_hi_u32_u24 v78, s42, v42
    v_mul_hi_u32_u24 v86, s44, v34
    v_mad_i32_i24 v70, v78, s43, v42
    v_lshlrev_b32 v78, 2, v78
    v_lshl_or_b32 v42, v86, 10, v78
    ds_add_rtn_u32 v54, v42, v3
    v_lshl_or_b32 v62, v70, 19, v34
    v_mul_hi_u32_u24 v79, s42, v43
    v_mul_hi_u32_u24 v87, s44, v35
    v_mad_i32_i24 v71, v79, s43, v43
    v_lshlrev_b32 v79, 2, v79
    v_lshl_or_b32 v43, v87, 10, v79
    ds_add_rtn_u32 v55, v43, v3
    v_lshl_or_b32 v63, v71, 19, v35
    s_waitcnt lgkmcnt(0)
    s_barrier
    s_cmp_lg_u32 s56, 0
    s_cbranch_scc1 L_scanskip_7
    v_mul_u32_u24 v96, 48, v0
    ds_read_b128 v[64:67], v96 offset:0
    ds_read_b128 v[68:71], v96 offset:16
    ds_read_b128 v[72:75], v96 offset:32
    v_mov_b32 v80, 0
    v_mov_b32 v81, 0
    v_mov_b32 v82, 0
    v_mov_b32 v83, 0
    v_mov_b32 v97, 0
    s_waitcnt lgkmcnt(0)
    ds_write_b128 v96, v[80:83] offset:0
    ds_write_b128 v96, v[80:83] offset:16
    ds_write_b128 v96, v[80:83] offset:32
    v_and_b32 v98, 2, v64
    v_mad_u32_u24 v98, v98, 3, v64
    v_add_u32 v97, v97, v98
    v_and_b32 v98, 2, v65
    v_mad_u32_u24 v98, v98, 3, v65
    v_mov_b32 v81, v97
    v_add_u32 v97, v97, v98
    v_and_b32 v98, 2, v66
    v_mad_u32_u24 v98, v98, 3, v66
    v_mov_b32 v82, v97
    v_add_u32 v97, v97, v98
    v_and_b32 v98, 2, v67
    v_mad_u32_u24 v98, v98, 3, v67
    v_mov_b32 v83, v97
    v_add_u32 v97, v97, v98
    v_and_b32 v98, 2, v68
    v_mad_u32_u24 v98, v98, 3, v68
    v_mov_b32 v84, v97
    v_add_u32 v97, v97, v98
    v_and_b32 v98, 2, v69
    v_mad_u32_u24 v98, v98, 3, v69
    v_mov_b32 v85, v97
    v_add_u32 v97, v97, v98
    v_and_b32 v98, 2, v70
    v_mad_u32_u24 v98, v98, 3, v70
    v_mov_b32 v86, v97
    v_add_u32 v97, v97, v98
    v_and_b32 v98, 2, v71
    v_mad_u32_u24 v98, v98, 3, v71
    v_mov_b32 v87, v97
    v_add_u32 v97, v97, v98
    v_and_b32 v98, 2, v72
    v_mad_u32_u24 v98, v98, 3, v72
    v_mov_b32 v88, v97
    v_add_u32 v97, v97, v98
    v_and_b32 v98, 2, v73
    v_mad_u32_u24 v98, v98, 3, v73
    v_mov_b32 v89, v97
    v_add_u32 v97, v97, v98
    v_and_b32 v98, 2, v74
    v_mad_u32_u24 v98, v98, 3, v74
    v_mov_b32 v90, v97
    v_add_u32 v97, v97, v98
    v_and_b32 v98, 2, v75
    v_mad_u32_u24 v98, v98, 3, v75
    v_mov_b32 v91, v97
    v_add_u32 v97, v97, v98
    v_mov_b32 v80, 0
    v_mov_b32 v98, v97
    s_nop 1
    v_add_u32_dpp v98, v98, v98 row_shr:1 row_mask:0xf bank_mask:0xf bound_ctrl:0
    s_nop 1
    v_add_u32_dpp v98, v98, v98 row_shr:2 row_mask:0xf bank_mask:0xf bound_ctrl:0
    s_nop 1
    v_add_u32_dpp v98, v98, v98 row_shr:4 row_mask:0xf bank_mask:0xf bound_ctrl:0
    s_nop 1
    v_add_u32_dpp v98, v98, v98 row_shr:8 row_mask:0xf bank_mask:0xf bound_ctrl:0
    s_nop 1
    v_add_u32_dpp v98, v98, v98 row_bcast:15 row_mask:0xa bank_mask:0xf
    s_nop 1
    v_add_u32_dpp v98, v98, v98 row_bcast:31 row_mask:0xc bank_mask:0xf
    s_nop 1
    v_mov_b32 v99, 6144
    s_mov_b32 exec_lo, 0
    s_mov_b32 exec_hi, 0x80000000
    ds_write_b32 v99, v98
    s_mov_b64 exec, -1
    v_sub_u32 v98, v98, v97
    v_add_u32 v99, 6400, v98
    v_add_u32 v80, v80, v99
    v_add_u32 v81, v81, v99
    v_add_u32 v82, v82, v99
    v_add_u32 v83, v83, v99
    v_add_u32 v84, v84, v99
    v_add_u32 v85, v85, v99
    v_add_u32 v86, v86, v99
    v_add_u32 v87, v87, v99
    v_add_u32 v88, v88, v99
    v_add_u32 v89, v89, v99
    v_add_u32 v90, v90, v99
    v_add_u32 v91, v91, v99
    ds_write_b128 v96, v[80:83] offset:3072
    ds_write_b128 v96, v[84:87] offset:3088
    ds_write_b128 v96, v[88:91] offset:3104
    s_waitcnt lgkmcnt(0)
L_scanskip_7:
    s_barrier
    ds_read_b32 v104, v36 offset:3072
    ds_read_b32 v105, v37 offset:3072
    ds_read_b32 v106, v38 offset:3072
    ds_read_b32 v107, v39 offset:3072
    ds_read_b32 v108, v40 offset:3072
    ds_read_b32 v109, v41 offset:3072
    ds_read_b32 v110, v42 offset:3072
    ds_read_b32 v111, v43 offset:3072
    v_mov_b32 v6, 6144
    ds_read_b32 v6, v6
    s_waitcnt lgkmcnt(8)
    v_add_u32 v104, v104, v48
    v_and_b32 v112, 2, v104
    v_sub_u32 v104, v104, v112
    v_sub_u32 v112, v104, v112
    ds_write_b32 v104, v56
    ds_write_b16 v112, v44 offset:8
    s_waitcnt lgkmcnt(9)
    v_add_u32 v105, v105, v49
    v_and_b32 v113, 2, v105
    v_sub_u32 v105, v105, v113
    v_sub_u32 v113, v105, v113
    ds_write_b32 v105, v57
    ds_write_b16_d16_hi v113, v44 offset:8
    s_waitcnt lgkmcnt(10)
    v_add_u32 v106, v106, v50
    v_and_b32 v114, 2, v106
    v_sub_u32 v106, v106, v114
    v_sub_u32 v114, v106, v114
    ds_write_b32 v106, v58
    ds_write_b16 v114, v45 offset:8
    s_waitcnt lgkmcnt(11)
    v_add_u32 v107, v107, v51
    v_and_b32 v115, 2, v107
    v_sub_u32 v107, v107, v115
    v_sub_u32 v115, v107, v115
    ds_write_b32 v107, v59
    ds_write_b16_d16_hi v115, v45 offset:8
    s_waitcnt lgkmcnt(12)
    v_add_u32 v108, v108, v52
    v_and_b32 v116, 2, v108
    v_sub_u32 v108, v108, v116
    v_sub_u32 v116, v108, v116
    ds_write_b32 v108, v60
    ds_write_b16 v116, v46 offset:8
    s_waitcnt lgkmcnt(13)
    v_add_u32 v109, v109, v53
    v_and_b32 v117, 2, v109
    v_sub_u32 v109, v109, v117
    v_sub_u32 v117, v109, v117
    ds_write_b32 v109, v61
    ds_write_b16_d16_hi v117, v46 offset:8
    s_waitcnt lgkmcnt(14)
    v_add_u32 v110, v110, v54
    v_and_b32 v118, 2, v110
    v_sub_u32 v110, v110, v118
    v_sub_u32 v118, v110, v118
    ds_write_b32 v110, v62
    ds_write_b16 v118, v47 offset:8
    s_waitcnt lgkmcnt(15)
    v_add_u32 v111, v111, v55
    v_and_b32 v119, 2, v111
    v_sub_u32 v111, v111, v119
    v_sub_u32 v119, v111, v119
    ds_write_b32 v111, v63
    ds_write_b16_d16_hi v119, v47 offset:8
    s_cmp_lg_u32 s56, 0
    s_cbranch_scc1 L_dskip_8
    s_mov_b32 s3, 43691
    v_mul_u32_u24 v64, s3, v64
    v_subrev_u32 v80, 6400, v80
    v_mul_u32_u24 v65, s3, v65
    v_subrev_u32 v81, 6400, v81
    v_mul_u32_u24 v66, s3, v66
    v_subrev_u32 v82, 6400, v82
    v_mul_u32_u24 v67, s3, v67
    v_subrev_u32 v83, 6400, v83
    v_mul_u32_u24 v68, s3, v68
    v_subrev_u32 v84, 6400, v84
    v_mul_u32_u24 v69, s3, v69
    v_subrev_u32 v85, 6400, v85
    v_mul_u32_u24 v70, s3, v70
    v_subrev_u32 v86, 6400, v86
    v_mul_u32_u24 v71, s3, v71
    v_subrev_u32 v87, 6400, v87
    v_mul_u32_u24 v72, s3, v72
    v_subrev_u32 v88, 6400, v88
    v_mul_u32_u24 v73, s3, v73
    v_subrev_u32 v89, 6400, v89
    v_mul_u32_u24 v74, s3, v74
    v_subrev_u32 v90, 6400, v90
    v_mul_u32_u24 v75, s3, v75
    v_subrev_u32 v91, 6400, v91
    v_lshrrev_b32 v64, 18, v64
    v_lshrrev_b32 v80, 2, v80
    v_lshrrev_b32 v65, 18, v65
    v_lshrrev_b32 v81, 2, v81
    v_lshrrev_b32 v66, 18, v66
    v_lshrrev_b32 v82, 2, v82
    v_lshrrev_b32 v67, 18, v67
    v_lshrrev_b32 v83, 2, v83
    v_lshrrev_b32 v68, 18, v68
    v_lshrrev_b32 v84, 2, v84
    v_lshrrev_b32 v69, 18, v69
    v_lshrrev_b32 v85, 2, v85
    v_lshrrev_b32 v70, 18, v70
    v_lshrrev_b32 v86, 2, v86
    v_lshrrev_b32 v71, 18, v71
    v_lshrrev_b32 v87, 2, v87
    v_lshrrev_b32 v72, 18, v72
    v_lshrrev_b32 v88, 2, v88
    v_lshrrev_b32 v73, 18, v73
    v_lshrrev_b32 v89, 2, v89
    v_lshrrev_b32 v74, 18, v74
    v_lshrrev_b32 v90, 2, v90
    v_lshrrev_b32 v75, 18, v75
    v_lshrrev_b32 v91, 2, v91
    v_lshl_or_b32 v64, v64, 16, v80
    v_lshl_or_b32 v65, v65, 16, v81
    v_lshl_or_b32 v66, v66, 16, v82
    v_lshl_or_b32 v67, v67, 16, v83
    v_lshl_or_b32 v68, v68, 16, v84
    v_lshl_or_b32 v69, v69, 16, v85
    v_lshl_or_b32 v70, v70, 16, v86
    v_lshl_or_b32 v71, v71, 16, v87
    v_lshl_or_b32 v72, v72, 16, v88
    v_lshl_or_b32 v73, v73, 16, v89
    v_lshl_or_b32 v74, v74, 16, v90
    v_lshl_or_b32 v75, v75, 16, v91
    v_mul_u32_u24 v96, 12, v0
    v_add_u32 v97, 0, v96
    v_and_b32 v98, 255, v97
    v_lshrrev_b32 v97, 8, v97
    v_mad_u32_u24 v98, v98, 15, v97
    v_lshlrev_b32 v80, 2, v98
    v_add_u32 v97, 1, v96
    v_and_b32 v98, 255, v97
    v_lshrrev_b32 v97, 8, v97
    v_mad_u32_u24 v98, v98, 15, v97
    v_lshlrev_b32 v81, 2, v98
    v_add_u32 v97, 2, v96
    v_and_b32 v98, 255, v97
    v_lshrrev_b32 v97, 8, v97
    v_mad_u32_u24 v98, v98, 15, v97
    v_lshlrev_b32 v82, 2, v98
    v_add_u32 v97, 3, v96
    v_and_b32 v98, 255, v97
    v_lshrrev_b32 v97, 8, v97
    v_mad_u32_u24 v98, v98, 15, v97
    v_lshlrev_b32 v83, 2, v98
    v_add_u32 v97, 4, v96
    v_and_b32 v98, 255, v97
    v_lshrrev_b32 v97, 8, v97
    v_mad_u32_u24 v98, v98, 15, v97
    v_lshlrev_b32 v84, 2, v98
    v_add_u32 v97, 5, v96
    v_and_b32 v98, 255, v97
    v_lshrrev_b32 v97, 8, v97
    v_mad_u32_u24 v98, v98, 15, v97
    v_lshlrev_b32 v85, 2, v98
    v_add_u32 v97, 6, v96
    v_and_b32 v98, 255, v97
    v_lshrrev_b32 v97, 8, v97
    v_mad_u32_u24 v98, v98, 15, v97
    v_lshlrev_b32 v86, 2, v98
    v_add_u32 v97, 7, v96
    v_and_b32 v98, 255, v97
    v_lshrrev_b32 v97, 8, v97
    v_mad_u32_u24 v98, v98, 15, v97
    v_lshlrev_b32 v87, 2, v98
    v_add_u32 v97, 8, v96
    v_and_b32 v98, 255, v97
    v_lshrrev_b32 v97, 8, v97
    v_mad_u32_u24 v98, v98, 15, v97
    v_lshlrev_b32 v88, 2, v98
    v_add_u32 v97, 9, v96
    v_and_b32 v98, 255, v97
    v_lshrrev_b32 v97, 8, v97
    v_mad_u32_u24 v98, v98, 15, v97
    v_lshlrev_b32 v89, 2, v98
    v_add_u32 v97, 10, v96
    v_and_b32 v98, 255, v97
    v_lshrrev_b32 v97, 8, v97
    v_mad_u32_u24 v98, v98, 15, v97
    v_lshlrev_b32 v90, 2, v98
    v_add_u32 v97, 11, v96
    v_and_b32 v98, 255, v97
    v_lshrrev_b32 v97, 8, v97
    v_mad_u32_u24 v98, v98, 15, v97
    v_lshlrev_b32 v91, 2, v98
    v_mov_b32 v97, 60196
    v_add_u32 v80, v80, v97
    v_add_u32 v81, v81, v97
    v_add_u32 v82, v82, v97
    v_add_u32 v83, v83, v97
    v_add_u32 v84, v84, v97
    v_add_u32 v85, v85, v97
    v_add_u32 v86, v86, v97
    v_add_u32 v87, v87, v97
    v_add_u32 v88, v88, v97
    v_add_u32 v89, v89, v97
    v_add_u32 v90, v90, v97
    v_add_u32 v91, v91, v97
    ds_write_b32 v80, v64
    ds_write_b32 v81, v65
    ds_write_b32 v82, v66
    ds_write_b32 v83, v67
    ds_write_b32 v84, v68
    ds_write_b32 v85, v69
    ds_write_b32 v86, v70
    ds_write_b32 v87, v71
    ds_write_b32 v88, v72
    ds_write_b32 v89, v73
    ds_write_b32 v90, v74
    ds_write_b32 v91, v75
L_dskip_8:
    s_waitcnt lgkmcnt(0)
    v_subrev_u32 v6, 49152, v6
    v_cmp_gt_i32 vcc, v6, v1
    s_mov_b64 s[38:39], vcc
    s_barrier
    ds_read_b128 v[48:51], v5 offset:0
    ds_read_b128 v[52:55], v5 offset:16384
    ds_read_b128 v[56:59], v5 offset:32768
    s_mov_b64 exec, s[38:39]
    ds_read_b128 v[60:63], v5 offset:49152
    s_mov_b64 exec, -1
    s_add_u32 s53, s52, 0
    s_waitcnt lgkmcnt(3)
    buffer_store_dwordx4 v[48:51], v1, s[24:27], s53 offen sc1
    s_add_u32 s53, s52, 16384
    s_waitcnt lgkmcnt(2)
    buffer_store_dwordx4 v[52:55], v1, s[24:27], s53 offen sc1
    s_add_u32 s53, s52, 32768
    s_waitcnt lgkmcnt(1)
    buffer_store_dwordx4 v[56:59], v1, s[24:27], s53 offen sc1
    s_add_u32 s53, s52, 49152
    s_mov_b64 exec, s[38:39]
    s_waitcnt lgkmcnt(0)
    buffer_store_dwordx4 v[60:63], v1, s[24:27], s53 offen sc1
    s_mov_b64 exec, -1
    s_add_u32 s52, s52, 13762560
    s_add_u32 s54, s54, 786432
    s_waitcnt vmcnt(4)
    v_mul_hi_u32_u24 v72, s42, v16
    v_mul_hi_u32_u24 v80, s44, v8
    v_mad_i32_i24 v64, v72, s43, v16
    v_lshlrev_b32 v72, 2, v72
    v_lshl_or_b32 v16, v80, 10, v72
    ds_add_rtn_u32 v48, v16, v3
    v_lshl_or_b32 v56, v64, 19, v8
    v_mul_hi_u32_u24 v73, s42, v17
    v_mul_hi_u32_u24 v81, s44, v9
    v_mad_i32_i24 v65, v73, s43, v17
    v_lshlrev_b32 v73, 2, v73
    v_lshl_or_b32 v17, v81, 10, v73
    ds_add_rtn_u32 v49, v17, v3
    v_lshl_or_b32 v57, v65, 19, v9
    v_mul_hi_u32_u24 v74, s42, v18
    v_mul_hi_u32_u24 v82, s44, v10
    v_mad_i32_i24 v66, v74, s43, v18
    v_lshlrev_b32 v74, 2, v74
    v_lshl_or_b32 v18, v82, 10, v74
    ds_add_rtn_u32 v50, v18, v3
    v_lshl_or_b32 v58, v66, 19, v10
    v_mul_hi_u32_u24 v75, s42, v19
    v_mul_hi_u32_u24 v83, s44, v11
    v_mad_i32_i24 v67, v75, s43, v19
    v_lshlrev_b32 v75, 2, v75
    v_lshl_or_b32 v19, v83, 10, v75
    ds_add_rtn_u32 v51, v19, v3
    v_lshl_or_b32 v59, v67, 19, v11
    s_mov_b64 exec, s[36:37]
    v_mul_hi_u32_u24 v76, s42, v20
    v_mul_hi_u32_u24 v84, s44, v12
    v_mad_i32_i24 v68, v76, s43, v20
    v_lshlrev_b32 v76, 2, v76
    v_lshl_or_b32 v20, v84, 10, v76
    ds_add_rtn_u32 v52, v20, v3
    v_lshl_or_b32 v60, v68, 19, v12
    v_mul_hi_u32_u24 v77, s42, v21
    v_mul_hi_u32_u24 v85, s44, v13
    v_mad_i32_i24 v69, v77, s43, v21
    v_lshlrev_b32 v77, 2, v77
    v_lshl_or_b32 v21, v85, 10, v77
    ds_add_rtn_u32 v53, v21, v3
    v_lshl_or_b32 v61, v69, 19, v13
    v_mul_hi_u32_u24 v78, s42, v22
    v_mul_hi_u32_u24 v86, s44, v14
    v_mad_i32_i24 v70, v78, s43, v22
    v_lshlrev_b32 v78, 2, v78
    v_lshl_or_b32 v22, v86, 10, v78
    ds_add_rtn_u32 v54, v22, v3
    v_lshl_or_b32 v62, v70, 19, v14
    v_mul_hi_u32_u24 v79, s42, v23
    v_mul_hi_u32_u24 v87, s44, v15
    v_mad_i32_i24 v71, v79, s43, v23
    v_lshlrev_b32 v79, 2, v79
    v_lshl_or_b32 v23, v87, 10, v79
    ds_add_rtn_u32 v55, v23, v3
    v_lshl_or_b32 v63, v71, 19, v15
    s_mov_b64 exec, -1
    s_waitcnt lgkmcnt(0)
    s_barrier
    s_cmp_lg_u32 s56, 0
    s_cbranch_scc1 L_scanskip_9
    v_mul_u32_u24 v96, 48, v0
    ds_read_b128 v[64:67], v96 offset:0
    ds_read_b128 v[68:71], v96 offset:16
    ds_read_b128 v[72:75], v96 offset:32
    v_mov_b32 v80, 0
    v_mov_b32 v81, 0
    v_mov_b32 v82, 0
    v_mov_b32 v83, 0
    v_mov_b32 v97, 0
    s_waitcnt lgkmcnt(0)
    ds_write_b128 v96, v[80:83] offset:0
    ds_write_b128 v96, v[80:83] offset:16
    ds_write_b128 v96, v[80:83] offset:32
    v_and_b32 v98, 2, v64
    v_mad_u32_u24 v98, v98, 3, v64
    v_add_u32 v97, v97, v98
    v_and_b32 v98, 2, v65
    v_mad_u32_u24 v98, v98, 3, v65
    v_mov_b32 v81, v97
    v_add_u32 v97, v97, v98
    v_and_b32 v98, 2, v66
    v_mad_u32_u24 v98, v98, 3, v66
    v_mov_b32 v82, v97
    v_add_u32 v97, v97, v98
    v_and_b32 v98, 2, v67
    v_mad_u32_u24 v98, v98, 3, v67
    v_mov_b32 v83, v97
    v_add_u32 v97, v97, v98
    v_and_b32 v98, 2, v68
    v_mad_u32_u24 v98, v98, 3, v68
    v_mov_b32 v84, v97
    v_add_u32 v97, v97, v98
    v_and_b32 v98, 2, v69
    v_mad_u32_u24 v98, v98, 3, v69
    v_mov_b32 v85, v97
    v_add_u32 v97, v97, v98
    v_and_b32 v98, 2, v70
    v_mad_u32_u24 v98, v98, 3, v70
    v_mov_b32 v86, v97
    v_add_u32 v97, v97, v98
    v_and_b32 v98, 2, v71
    v_mad_u32_u24 v98, v98, 3, v71
    v_mov_b32 v87, v97
    v_add_u32 v97, v97, v98
    v_and_b32 v98, 2, v72
    v_mad_u32_u24 v98, v98, 3, v72
    v_mov_b32 v88, v97
    v_add_u32 v97, v97, v98
    v_and_b32 v98, 2, v73
    v_mad_u32_u24 v98, v98, 3, v73
    v_mov_b32 v89, v97
    v_add_u32 v97, v97, v98
    v_and_b32 v98, 2, v74
    v_mad_u32_u24 v98, v98, 3, v74
    v_mov_b32 v90, v97
    v_add_u32 v97, v97, v98
    v_and_b32 v98, 2, v75
    v_mad_u32_u24 v98, v98, 3, v75
    v_mov_b32 v91, v97
    v_add_u32 v97, v97, v98
    v_mov_b32 v80, 0
    v_mov_b32 v98, v97
    s_nop 1
    v_add_u32_dpp v98, v98, v98 row_shr:1 row_mask:0xf bank_mask:0xf bound_ctrl:0
    s_nop 1
    v_add_u32_dpp v98, v98, v98 row_shr:2 row_mask:0xf bank_mask:0xf bound_ctrl:0
    s_nop 1
    v_add_u32_dpp v98, v98, v98 row_shr:4 row_mask:0xf bank_mask:0xf bound_ctrl:0
    s_nop 1
    v_add_u32_dpp v98, v98, v98 row_shr:8 row_mask:0xf bank_mask:0xf bound_ctrl:0
    s_nop 1
    v_add_u32_dpp v98, v98, v98 row_bcast:15 row_mask:0xa bank_mask:0xf
    s_nop 1
    v_add_u32_dpp v98, v98, v98 row_bcast:31 row_mask:0xc bank_mask:0xf
    s_nop 1
    v_mov_b32 v99, 6144
    s_mov_b32 exec_lo, 0
    s_mov_b32 exec_hi, 0x80000000
    ds_write_b32 v99, v98
    s_mov_b64 exec, -1
    v_sub_u32 v98, v98, v97
    v_add_u32 v99, 6400, v98
    v_add_u32 v80, v80, v99
    v_add_u32 v81, v81, v99
    v_add_u32 v82, v82, v99
    v_add_u32 v83, v83, v99
    v_add_u32 v84, v84, v99
    v_add_u32 v85, v85, v99
    v_add_u32 v86, v86, v99
    v_add_u32 v87, v87, v99
    v_add_u32 v88, v88, v99
    v_add_u32 v89, v89, v99
    v_add_u32 v90, v90, v99
    v_add_u32 v91, v91, v99
    ds_write_b128 v96, v[80:83] offset:3072
    ds_write_b128 v96, v[84:87] offset:3088
    ds_write_b128 v96, v[88:91] offset:3104
    s_waitcnt lgkmcnt(0)
L_scanskip_9:
    s_barrier
    ds_read_b32 v104, v16 offset:3072
    ds_read_b32 v105, v17 offset:3072
    ds_read_b32 v106, v18 offset:3072
    ds_read_b32 v107, v19 offset:3072
    s_mov_b64 exec, s[36:37]
    ds_read_b32 v108, v20 offset:3072
    ds_read_b32 v109, v21 offset:3072
    ds_read_b32 v110, v22 offset:3072
    ds_read_b32 v111, v23 offset:3072
    s_mov_b64 exec, -1
    v_mov_b32 v6, 6144
    ds_read_b32 v6, v6
    s_waitcnt lgkmcnt(8)
    v_add_u32 v104, v104, v48
    v_and_b32 v112, 2, v104
    v_sub_u32 v104, v104, v112
    v_sub_u32 v112, v104, v112
    ds_write_b32 v104, v56
    ds_write_b16 v112, v24 offset:8
    s_waitcnt lgkmcnt(9)
    v_add_u32 v105, v105, v49
    v_and_b32 v113, 2, v105
    v_sub_u32 v105, v105, v113
    v_sub_u32 v113, v105, v113
    ds_write_b32 v105, v57
    ds_write_b16_d16_hi v113, v24 offset:8
    s_waitcnt lgkmcnt(10)
    v_add_u32 v106, v106, v50
    v_and_b32 v114, 2, v106
    v_sub_u32 v106, v106, v114
    v_sub_u32 v114, v106, v114
    ds_write_b32 v106, v58
    ds_write_b16 v114, v25 offset:8
    s_waitcnt lgkmcnt(11)
    v_add_u32 v107, v107, v51
    v_and_b32 v115, 2, v107
    v_sub_u32 v107, v107, v115
    v_sub_u32 v115, v107, v115
    ds_write_b32 v107, v59
    ds_write_b16_d16_hi v115, v25 offset:8
    s_waitcnt lgkmcnt(12)
    s_mov_b64 exec, s[36:37]
    v_add_u32 v108, v108, v52
    v_and_b32 v116, 2, v108
    v_sub_u32 v108, v108, v116
    v_sub_u32 v116, v108, v116
    ds_write_b32 v108, v60
    ds_write_b16 v116, v26 offset:8
    s_waitcnt lgkmcnt(13)
    v_add_u32 v109, v109, v53
    v_and_b32 v117, 2, v109
    v_sub_u32 v109, v109, v117
    v_sub_u32 v117, v109, v117
    ds_write_b32 v109, v61
    ds_write_b16_d16_hi v117, v26 offset:8
    s_waitcnt lgkmcnt(14)
    v_add_u32 v110, v110, v54
    v_and_b32 v118, 2, v110
    v_sub_u32 v110, v110, v118
    v_sub_u32 v118, v110, v118
    ds_write_b32 v110, v62
    ds_write_b16 v118, v27 offset:8
    s_waitcnt lgkmcnt(15)
    v_add_u32 v111, v111, v55
    v_and_b32 v119, 2, v111
    v_sub_u32 v111, v111, v119
    v_sub_u32 v119, v111, v119
    ds_write_b32 v111, v63
    ds_write_b16_d16_hi v119, v27 offset:8
    s_mov_b64 exec, -1
    s_cmp_lg_u32 s56, 0
    s_cbranch_scc1 L_dskip_10
    s_mov_b32 s3, 43691
    v_mul_u32_u24 v64, s3, v64
    v_subrev_u32 v80, 6400, v80
    v_mul_u32_u24 v65, s3, v65
    v_subrev_u32 v81, 6400, v81
    v_mul_u32_u24 v66, s3, v66
    v_subrev_u32 v82, 6400, v82
    v_mul_u32_u24 v67, s3, v67
    v_subrev_u32 v83, 6400, v83
    v_mul_u32_u24 v68, s3, v68
    v_subrev_u32 v84, 6400, v84
    v_mul_u32_u24 v69, s3, v69
    v_subrev_u32 v85, 6400, v85
    v_mul_u32_u24 v70, s3, v70
    v_subrev_u32 v86, 6400, v86
    v_mul_u32_u24 v71, s3, v71
    v_subrev_u32 v87, 6400, v87
    v_mul_u32_u24 v72, s3, v72
    v_subrev_u32 v88, 6400, v88
    v_mul_u32_u24 v73, s3, v73
    v_subrev_u32 v89, 6400, v89
    v_mul_u32_u24 v74, s3, v74
    v_subrev_u32 v90, 6400, v90
    v_mul_u32_u24 v75, s3, v75
    v_subrev_u32 v91, 6400, v91
    v_lshrrev_b32 v64, 18, v64
    v_lshrrev_b32 v80, 2, v80
    v_lshrrev_b32 v65, 18, v65
    v_lshrrev_b32 v81, 2, v81
    v_lshrrev_b32 v66, 18, v66
    v_lshrrev_b32 v82, 2, v82
    v_lshrrev_b32 v67, 18, v67
    v_lshrrev_b32 v83, 2, v83
    v_lshrrev_b32 v68, 18, v68
    v_lshrrev_b32 v84, 2, v84
    v_lshrrev_b32 v69, 18, v69
    v_lshrrev_b32 v85, 2, v85
    v_lshrrev_b32 v70, 18, v70
    v_lshrrev_b32 v86, 2, v86
    v_lshrrev_b32 v71, 18, v71
    v_lshrrev_b32 v87, 2, v87
    v_lshrrev_b32 v72, 18, v72
    v_lshrrev_b32 v88, 2, v88
    v_lshrrev_b32 v73, 18, v73
    v_lshrrev_b32 v89, 2, v89
    v_lshrrev_b32 v74, 18, v74
    v_lshrrev_b32 v90, 2, v90
    v_lshrrev_b32 v75, 18, v75
    v_lshrrev_b32 v91, 2, v91
    v_lshl_or_b32 v64, v64, 16, v80
    v_lshl_or_b32 v65, v65, 16, v81
    v_lshl_or_b32 v66, v66, 16, v82
    v_lshl_or_b32 v67, v67, 16, v83
    v_lshl_or_b32 v68, v68, 16, v84
    v_lshl_or_b32 v69, v69, 16, v85
    v_lshl_or_b32 v70, v70, 16, v86
    v_lshl_or_b32 v71, v71, 16, v87
    v_lshl_or_b32 v72, v72, 16, v88
    v_lshl_or_b32 v73, v73, 16, v89
    v_lshl_or_b32 v74, v74, 16, v90
    v_lshl_or_b32 v75, v75, 16, v91
    v_mul_u32_u24 v96, 12, v0
    v_add_u32 v97, 0, v96
    v_and_b32 v98, 255, v97
    v_lshrrev_b32 v97, 8, v97
    v_mad_u32_u24 v98, v98, 15, v97
    v_lshlrev_b32 v80, 2, v98
    v_add_u32 v97, 1, v96
    v_and_b32 v98, 255, v97
    v_lshrrev_b32 v97, 8, v97
    v_mad_u32_u24 v98, v98, 15, v97
    v_lshlrev_b32 v81, 2, v98
    v_add_u32 v97, 2, v96
    v_and_b32 v98, 255, v97
    v_lshrrev_b32 v97, 8, v97
    v_mad_u32_u24 v98, v98, 15, v97
    v_lshlrev_b32 v82, 2, v98
    v_add_u32 v97, 3, v96
    v_and_b32 v98, 255, v97
    v_lshrrev_b32 v97, 8, v97
    v_mad_u32_u24 v98, v98, 15, v97
    v_lshlrev_b32 v83, 2, v98
    v_add_u32 v97, 4, v96
    v_and_b32 v98, 255, v97
    v_lshrrev_b32 v97, 8, v97
    v_mad_u32_u24 v98, v98, 15, v97
    v_lshlrev_b32 v84, 2, v98
    v_add_u32 v97, 5, v96
    v_and_b32 v98, 255, v97
    v_lshrrev_b32 v97, 8, v97
    v_mad_u32_u24 v98, v98, 15, v97
    v_lshlrev_b32 v85, 2, v98
    v_add_u32 v97, 6, v96
    v_and_b32 v98, 255, v97
    v_lshrrev_b32 v97, 8, v97
    v_mad_u32_u24 v98, v98, 15, v97
    v_lshlrev_b32 v86, 2, v98
    v_add_u32 v97, 7, v96
    v_and_b32 v98, 255, v97
    v_lshrrev_b32 v97, 8, v97
    v_mad_u32_u24 v98, v98, 15, v97
    v_lshlrev_b32 v87, 2, v98
    v_add_u32 v97, 8, v96
    v_and_b32 v98, 255, v97
    v_lshrrev_b32 v97, 8, v97
    v_mad_u32_u24 v98, v98, 15, v97
    v_lshlrev_b32 v88, 2, v98
    v_add_u32 v97, 9, v96
    v_and_b32 v98, 255, v97
    v_lshrrev_b32 v97, 8, v97
    v_mad_u32_u24 v98, v98, 15, v97
    v_lshlrev_b32 v89, 2, v98
    v_add_u32 v97, 10, v96
    v_and_b32 v98, 255, v97
    v_lshrrev_b32 v97, 8, v97
    v_mad_u32_u24 v98, v98, 15, v97
    v_lshlrev_b32 v90, 2, v98
    v_add_u32 v97, 11, v96
    v_and_b32 v98, 255, v97
    v_lshrrev_b32 v97, 8, v97
    v_mad_u32_u24 v98, v98, 15, v97
    v_lshlrev_b32 v91, 2, v98
    v_mov_b32 v97, 60208
    v_add_u32 v80, v80, v97
    v_add_u32 v81, v81, v97
    v_add_u32 v82, v82, v97
    v_add_u32 v83, v83, v97
    v_add_u32 v84, v84, v97
    v_add_u32 v85, v85, v97
    v_add_u32 v86, v86, v97
    v_add_u32 v87, v87, v97
    v_add_u32 v88, v88, v97
    v_add_u32 v89, v89, v97
    v_add_u32 v90, v90, v97
    v_add_u32 v91, v91, v97
    ds_write_b32 v80, v64
    ds_write_b32 v81, v65
    ds_write_b32 v82, v66
    ds_write_b32 v83, v67
    ds_write_b32 v84, v68
    ds_write_b32 v85, v69
    ds_write_b32 v86, v70
    ds_write_b32 v87, v71
    ds_write_b32 v88, v72
    ds_write_b32 v89, v73
    ds_write_b32 v90, v74
    ds_write_b32 v91, v75
L_dskip_10:
    s_waitcnt lgkmcnt(0)
    v_subrev_u32 v6, 32768, v6
    v_cmp_gt_i32 vcc, v6, v1
    s_mov_b64 s[40:41], vcc
    v_subrev_u32 v6, 16384, v6
    v_cmp_gt_i32 vcc, v6, v1
    s_mov_b64 s[38:39], vcc
    s_barrier
    ds_read_b128 v[48:51], v5 offset:0
    ds_read_b128 v[52:55], v5 offset:16384
    s_mov_b64 exec, s[40:41]
    ds_read_b128 v[56:59], v5 offset:32768
    s_mov_b64 exec, s[38:39]
    ds_read_b128 v[60:63], v5 offset:49152
    s_mov_b64 exec, -1
    s_add_u32 s53, s52, 0
    s_waitcnt lgkmcnt(3)
    buffer_store_dwordx4 v[48:51], v1, s[24:27], s53 offen sc1
    s_add_u32 s53, s52, 16384
    s_waitcnt lgkmcnt(2)
    buffer_store_dwordx4 v[52:55], v1, s[24:27], s53 offen sc1
    s_add_u32 s53, s52, 32768
    s_mov_b64 exec, s[40:41]
    s_waitcnt lgkmcnt(1)
    buffer_store_dwordx4 v[56:59], v1, s[24:27], s53 offen sc1
    s_add_u32 s53, s52, 49152
    s_mov_b64 exec, s[38:39]
    s_waitcnt lgkmcnt(0)
    buffer_store_dwordx4 v[60:63], v1, s[24:27], s53 offen sc1
    s_mov_b64 exec, -1
    s_add_u32 s52, s52, 13762560
    s_add_u32 s54, s54, 786432
gsm_part_kernel_fin:
    s_waitcnt lgkmcnt(0)
    s_barrier
    v_add_u32 v48, 60160, v1
    v_cmp_gt_u32 vcc, 960, v0
    s_mov_b64 exec, vcc
    ds_read_b128 v[52:55], v48
    s_mul_i32 s3, s2, 15360
    s_add_u32 s3, s3, 69206016
    s_waitcnt lgkmcnt(0)
    buffer_store_dwordx4 v[52:55], v1, s[24:27], s3 offen
    s_mov_b64 exec, -1
gsm_part_kernel_done:
    s_endpgm
.globl gsm_acc_kernel
.p2align 8
.type gsm_acc_kernel,@function
gsm_acc_kernel:
    s_cmp_ge_u32 s2, 256
    s_cbranch_scc1 gsm_acc_kernel_done
    s_load_dwordx2 s[96:97], s[0:1], 104
    s_load_dwordx2 s[90:91], s[0:1], 96
    s_load_dwordx2 s[86:87], s[0:1], 24
    s_load_dwordx2 s[84:85], s[0:1], 0
    s_load_dwordx2 s[88:89], s[0:1], 40
    s_load_dwordx4 s[92:95], s[0:1], 56
    v_lshrrev_b32 v1, 6, v0
    v_and_b32 v2, 63, v0
    v_lshlrev_b32 v3, 4, v0
    v_readfirstlane_b32 s5, v1
    v_mul_u32_u24 v13, 3072, v0
    v_mov_b32 v14, 0
    v_mov_b32 v15, 0
    v_mov_b32 v16, 0
    v_mov_b32 v17, 0
    v_mov_b32 v18, 0
    v_mov_b32 v19, 0
    v_mov_b32 v20, 0
    v_mov_b32 v21, 0
    s_waitcnt lgkmcnt(0)
    s_mov_b32 s12, s96
    s_and_b32 s13, s97, 0xffff
    s_mov_b32 s14, 268435456
    s_mov_b32 s15, 0x00020000
    s_mov_b32 s8, s84
    s_and_b32 s9, s85, 0xffff
    s_or_b32 s9, s9, 0x80000
    s_mov_b32 s10, 320000
    s_mov_b32 s11, 0x00020000
    s_mov_b32 s16, s86
    s_and_b32 s17, s87, 0xffff
    s_mov_b32 s18, 640000
    s_mov_b32 s19, 0x00020000
    s_mov_b32 s6, 73138176
    buffer_load_dwordx4 v[24:27], v3, s[12:15], s6 offen
    s_load_dwordx16 s[20:35], s[94:95], 0
    s_load_dwordx16 s[36:51], s[94:95], 64
    s_load_dwordx16 s[52:67], s[94:95], 128
    s_load_dwordx16 s[68:83], s[92:93], 0
    s_load_dwordx4 s[96:99], s[88:89], 0
    v_mov_b32 v32, 0
    v_mov_b32 v33, 0
    v_mov_b32 v34, 0
    v_mov_b32 v35, 0
    ds_write_b128 v3, v[32:35]
    v_cmp_gt_u32 vcc, 850, v0
    s_mov_b64 exec, vcc
    ds_write_b128 v3, v[32:35] offset:16384
    s_mov_b64 exec, -1
    s_and_b32 s3, s2, 7
    s_lshl_b32 s3, s3, 5
    s_lshr_b32 s4, s2, 3
    s_add_u32 s3, s3, s4
    s_mul_i32 s7, s3, 1250
    s_mul_i32 s4, s3, 60
    s_add_u32 s4, s4, 69206016
    v_lshrrev_b32 v29, 2, v0
    v_and_b32 v30, 3, v0
    v_mul_u32_u24 v13, 15360, v29
    v_lshl_add_u32 v13, v30, 4, v13
    buffer_load_dwordx4 v[14:17], v13, s[12:15], s4 offen
    v_add_u32 v28, s7, v0
    v_lshlrev_b32 v28, 1, v28
    v_mov_b32 v63, 0
    buffer_load_ushort v62, v28, s[16:19], 0 offen
    v_cmp_gt_u32 vcc, 226, v0
    s_mov_b64 exec, vcc
    buffer_load_ushort v63, v28, s[16:19], 0 offen offset:2048
    s_mov_b64 exec, -1
    v_lshrrev_b32 v30, 3, v0
    v_and_b32 v31, 7, v0
    v_mul_u32_u24 v4, 53760, v30
    v_mul_u32_u24 v5, 12, v31
    v_add_u32 v4, v4, v5
    v_lshlrev_b32 v5, 1, v31
    v_add_u32 v6, 1, v5
    v_mov_b32 v7, 0x4b400000
    v_mul_u32_u24 v8, 12, v30
    v_add_u32 v8, 59984, v8
    v_mov_b32 v9, 2
    s_lshl_b32 s4, s5, 7
    v_add_u32 v12, s4, v2
    v_lshlrev_b32 v10, 2, v12
    v_add_u32 v10, 75344, v10
    v_lshlrev_b32 v11, 1, v12
    v_add_u32 v11, 132688, v11
    v_and_b32 v38, 3, v0
    v_lshl_add_u32 v44, v38, 2, 0
    v_mul_u32_u24 v34, 11, v44
    v_lshrrev_b32 v34, 5, v34
    v_mul_u32_u24 v48, 3, v34
    v_sub_u32 v48, v44, v48
    v_lshlrev_b32 v48, 2, v48
    v_mul_u32_u24 v44, 3072, v34
    v_mad_u32_u24 v44, v29, 12, v44
    v_add_u32 v44, v44, v48
    v_add_u32 v44, 59984, v44
    v_lshlrev_b32 v34, 8, v34
    v_add_u32 v34, v34, v29
    v_lshl_add_u32 v45, v38, 2, 1
    v_mul_u32_u24 v35, 11, v45
    v_lshrrev_b32 v35, 5, v35
    v_mul_u32_u24 v49, 3, v35
    v_sub_u32 v49, v45, v49
    v_lshlrev_b32 v49, 2, v49
    v_mul_u32_u24 v45, 3072, v35
    v_mad_u32_u24 v45, v29, 12, v45
    v_add_u32 v45, v45, v49
    v_add_u32 v45, 59984, v45
    v_lshlrev_b32 v35, 8, v35
    v_add_u32 v35, v35, v29
    v_lshl_add_u32 v46, v38, 2, 2
    v_mul_u32_u24 v36, 11, v46
    v_lshrrev_b32 v36, 5, v36
    v_mul_u32_u24 v50, 3, v36
    v_sub_u32 v50, v46, v50
    v_lshlrev_b32 v50, 2, v50
    v_mul_u32_u24 v46, 3072, v36
    v_mad_u32_u24 v46, v29, 12, v46
    v_add_u32 v46, v46, v50
    v_add_u32 v46, 59984, v46
    v_lshlrev_b32 v36, 8, v36
    v_add_u32 v36, v36, v29
    v_lshl_add_u32 v47, v38, 2, 3
    v_mul_u32_u24 v37, 11, v47
    v_lshrrev_b32 v37, 5, v37
    v_mul_u32_u24 v51, 3, v37
    v_sub_u32 v51, v47, v51
    v_lshlrev_b32 v51, 2, v51
    v_mul_u32_u24 v47, 3072, v37
    v_mad_u32_u24 v47, v29, 12, v47
    v_add_u32 v47, v47, v51
    v_add_u32 v47, 59984, v47
    v_lshlrev_b32 v37, 8, v37
    v_add_u32 v37, v37, v29
    v_cmp_gt_u32 vcc, 3, v38
    s_mov_b64 s[100:101], vcc
    s_waitcnt lgkmcnt(0)
    s_barrier
    s_waitcnt vmcnt(2)
    v_cndmask_b32 v17, 0, v17, s[100:101]
    ds_write_b32 v44, v14
    ds_write_b32 v45, v15
    ds_write_b32 v46, v16
    s_mov_b64 exec, s[100:101]
    ds_write_b32 v47, v17
    s_mov_b64 exec, -1
    v_lshrrev_b32 v40, 16, v14
    v_lshrrev_b32 v41, 16, v15
    v_lshrrev_b32 v42, 16, v16
    v_lshrrev_b32 v43, 16, v17
    v_add3_u32 v52, v40, v41, v42
    v_add_u32 v52, v52, v43
    v_max3_u32 v53, v40, v41, v42
    v_max_u32 v53, v53, v43
    v_max_u32 v22, v24, v25
    v_max_u32 v24, v26, v27
    v_max_u32 v22, v22, v24
    s_nop 1
    v_add_u32_dpp v52, v52, v52 row_shr:1 row_mask:0xf bank_mask:0xf bound_ctrl:0
    s_nop 1
    v_add_u32_dpp v52, v52, v52 row_shr:2 row_mask:0xf bank_mask:0xf bound_ctrl:0
    s_nop 1
    v_add_u32_dpp v52, v52, v52 row_shr:4 row_mask:0xf bank_mask:0xf bound_ctrl:0
    s_nop 1
    v_add_u32_dpp v52, v52, v52 row_shr:8 row_mask:0xf bank_mask:0xf bound_ctrl:0
    s_nop 1
    v_add_u32_dpp v52, v52, v52 row_bcast:15 row_mask:0xa bank_mask:0xf
    s_nop 1
    v_add_u32_dpp v52, v52, v52 row_bcast:31 row_mask:0xc bank_mask:0xf
    s_nop 1
    v_max_u32_dpp v22, v22, v22 row_shr:1 row_mask:0xf bank_mask:0xf
    s_nop 1
    v_max_u32_dpp v22, v22, v22 row_shr:2 row_mask:0xf bank_mask:0xf
    s_nop 1
    v_max_u32_dpp v22, v22, v22 row_shr:4 row_mask:0xf bank_mask:0xf
    s_nop 1
    v_max_u32_dpp v22, v22, v22 row_shr:8 row_mask:0xf bank_mask:0xf
    s_nop 1
    v_max_u32_dpp v22, v22, v22 row_bcast:15 row_mask:0xa bank_mask:0xf
    s_nop 1
    v_max_u32_dpp v22, v22, v22 row_bcast:31 row_mask:0xc bank_mask:0xf
    s_nop 1
    v_mov_b32 v54, 8192
    s_mov_b32 exec_lo, 0
    s_mov_b32 exec_hi, 0x80000000
    ds_add_u32 v54, v52 offset:0
    ds_max_u32 v54, v22 offset:4
    s_mov_b64 exec, -1
    v_cmp_lt_u32 vcc, 16, v53
    s_cbranch_vccz L_nox_11
    v_mov_b32 v55, 1
    v_add_u32 v64, v54, v48
    v_cmp_lt_u32 vcc, 16, v40
    s_mov_b64 exec, vcc
    ds_add_rtn_u32 v68, v64, v55 offset:16
    s_mov_b64 exec, -1
    v_add_u32 v65, v54, v49
    v_cmp_lt_u32 vcc, 16, v41
    s_mov_b64 exec, vcc
    ds_add_rtn_u32 v69, v65, v55 offset:16
    s_mov_b64 exec, -1
    v_add_u32 v66, v54, v50
    v_cmp_lt_u32 vcc, 16, v42
    s_mov_b64 exec, vcc
    ds_add_rtn_u32 v70, v66, v55 offset:16
    s_mov_b64 exec, -1
    v_add_u32 v67, v54, v51
    v_cmp_lt_u32 vcc, 16, v43
    s_mov_b64 exec, vcc
    ds_add_rtn_u32 v71, v67, v55 offset:16
    s_mov_b64 exec, -1
    v_mul_u32_u24 v72, 13440, v34
    v_and_b32 v56, 0xffff, v14
    v_add3_u32 v72, v72, v56, 24
    v_subrev_u32 v76, 16, v40
    v_lshlrev_b32 v48, 7, v48
    v_mul_u32_u24 v73, 13440, v35
    v_and_b32 v56, 0xffff, v15
    v_add3_u32 v73, v73, v56, 24
    v_subrev_u32 v77, 16, v41
    v_lshlrev_b32 v49, 7, v49
    v_mul_u32_u24 v74, 13440, v36
    v_and_b32 v56, 0xffff, v16
    v_add3_u32 v74, v74, v56, 24
    v_subrev_u32 v78, 16, v42
    v_lshlrev_b32 v50, 7, v50
    v_mul_u32_u24 v75, 13440, v37
    v_and_b32 v56, 0xffff, v17
    v_add3_u32 v75, v75, v56, 24
    v_subrev_u32 v79, 16, v43
    v_lshlrev_b32 v51, 7, v51
    s_waitcnt lgkmcnt(0)
    v_cmp_lt_i32 vcc, 0, v76
    s_and_b64 exec, exec, vcc
    v_cmp_gt_u32 vcc, 128, v68
    s_mov_b64 s[100:101], exec
    s_and_b64 exec, exec, vcc
    v_min_u32 v57, 16, v76
    v_lshl_or_b32 v57, v57, 25, v72
    v_lshl_add_u32 v56, v68, 2, v48
    ds_write_b32 v56, v57 offset:8448
    s_mov_b64 exec, s[100:101]
    s_mov_b64 exec, -1
    v_cmp_lt_i32 vcc, 0, v77
    s_and_b64 exec, exec, vcc
    v_cmp_gt_u32 vcc, 128, v69
    s_mov_b64 s[100:101], exec
    s_and_b64 exec, exec, vcc
    v_min_u32 v57, 16, v77
    v_lshl_or_b32 v57, v57, 25, v73
    v_lshl_add_u32 v56, v69, 2, v49
    ds_write_b32 v56, v57 offset:8448
    s_mov_b64 exec, s[100:101]
    s_mov_b64 exec, -1
    v_cmp_lt_i32 vcc, 0, v78
    s_and_b64 exec, exec, vcc
    v_cmp_gt_u32 vcc, 128, v70
    s_mov_b64 s[100:101], exec
    s_and_b64 exec, exec, vcc
    v_min_u32 v57, 16, v78
    v_lshl_or_b32 v57, v57, 25, v74
    v_lshl_add_u32 v56, v70, 2, v50
    ds_write_b32 v56, v57 offset:8448
    s_mov_b64 exec, s[100:101]
    s_mov_b64 exec, -1
    v_cmp_lt_i32 vcc, 0, v79
    s_and_b64 exec, exec, vcc
    v_cmp_gt_u32 vcc, 128, v71
    s_mov_b64 s[100:101], exec
    s_and_b64 exec, exec, vcc
    v_min_u32 v57, 16, v79
    v_lshl_or_b32 v57, v57, 25, v75
    v_lshl_add_u32 v56, v71, 2, v51
    ds_write_b32 v56, v57 offset:8448
    s_mov_b64 exec, s[100:101]
    s_mov_b64 exec, -1
L_xb_12:
    v_add_u32 v72, 24, v72
    v_subrev_u32 v76, 16, v76
    v_cmp_lt_i32 vcc, 0, v76
    s_and_b64 exec, exec, vcc
    s_cbranch_execz L_xe_13
    ds_add_rtn_u32 v68, v64, v55 offset:16
    s_waitcnt lgkmcnt(0)
    v_cmp_lt_i32 vcc, 0, v76
    s_and_b64 exec, exec, vcc
    v_cmp_gt_u32 vcc, 128, v68
    s_mov_b64 s[100:101], exec
    s_and_b64 exec, exec, vcc
    v_min_u32 v57, 16, v76
    v_lshl_or_b32 v57, v57, 25, v72
    v_lshl_add_u32 v56, v68, 2, v48
    ds_write_b32 v56, v57 offset:8448
    s_mov_b64 exec, s[100:101]
    s_branch L_xb_12
L_xe_13:
    s_mov_b64 exec, -1
L_xb_14:
    v_add_u32 v73, 24, v73
    v_subrev_u32 v77, 16, v77
    v_cmp_lt_i32 vcc, 0, v77
    s_and_b64 exec, exec, vcc
    s_cbranch_execz L_xe_15
    ds_add_rtn_u32 v69, v65, v55 offset:16
    s_waitcnt lgkmcnt(0)
    v_cmp_lt_i32 vcc, 0, v77
    s_and_b64 exec, exec, vcc
    v_cmp_gt_u32 vcc, 128, v69
    s_mov_b64 s[100:101], exec
    s_and_b64 exec, exec, vcc
    v_min_u32 v57, 16, v77
    v_lshl_or_b32 v57, v57, 25, v73
    v_lshl_add_u32 v56, v69, 2, v49
    ds_write_b32 v56, v57 offset:8448
    s_mov_b64 exec, s[100:101]
    s_branch L_xb_14
L_xe_15:
    s_mov_b64 exec, -1
L_xb_16:
    v_add_u32 v74, 24, v74
    v_subrev_u32 v78, 16, v78
    v_cmp_lt_i32 vcc, 0, v78
    s_and_b64 exec, exec, vcc
    s_cbranch_execz L_xe_17
    ds_add_rtn_u32 v70, v66, v55 offset:16
    s_waitcnt lgkmcnt(0)
    v_cmp_lt_i32 vcc, 0, v78
    s_and_b64 exec, exec, vcc
    v_cmp_gt_u32 vcc, 128, v70
    s_mov_b64 s[100:101], exec
    s_and_b64 exec, exec, vcc
    v_min_u32 v57, 16, v78
    v_lshl_or_b32 v57, v57, 25, v74
    v_lshl_add_u32 v56, v70, 2, v50
    ds_write_b32 v56, v57 offset:8448
    s_mov_b64 exec, s[100:101]
    s_branch L_xb_16
L_xe_17:
    s_mov_b64 exec, -1
L_xb_18:
    v_add_u32 v75, 24, v75
    v_subrev_u32 v79, 16, v79
    v_cmp_lt_i32 vcc, 0, v79
    s_and_b64 exec, exec, vcc
    s_cbranch_execz L_xe_19
    ds_add_rtn_u32 v71, v67, v55 offset:16
    s_waitcnt lgkmcnt(0)
    v_cmp_lt_i32 vcc, 0, v79
    s_and_b64 exec, exec, vcc
    v_cmp_gt_u32 vcc, 128, v71
    s_mov_b64 s[100:101], exec
    s_and_b64 exec, exec, vcc
    v_min_u32 v57, 16, v79
    v_lshl_or_b32 v57, v57, 25, v75
    v_lshl_add_u32 v56, v71, 2, v51
    ds_write_b32 v56, v57 offset:8448
    s_mov_b64 exec, s[100:101]
    s_branch L_xb_18
L_xe_19:
    s_mov_b64 exec, -1
L_nox_11:
    s_waitcnt lgkmcnt(0)
    s_barrier
    v_lshrrev_b32 v60, 3, v0
    v_lshlrev_b32 v60, 2, v60
    v_add_u32 v60, 8448, v60
    ds_read_b32 v80, v8 offset:0
    ds_read_b32 v81, v8 offset:1536
    ds_read_b32 v82, v8 offset:3072
    ds_read_b32 v83, v8 offset:4608
    ds_read_b32 v84, v8 offset:6144
    ds_read_b32 v85, v8 offset:7680
    ds_read_b32 v86, v8 offset:9216
    ds_read_b32 v87, v8 offset:10752
    ds_read_b32 v88, v8 offset:12288
    ds_read_b32 v89, v8 offset:13824
    ds_read_b32 v90, v60
    v_mov_b32 v60, 8192
    ds_read_b64 v[58:59], v60 offset:0
    ds_read_b32 v61, v60 offset:16
    s_waitcnt vmcnt(0) lgkmcnt(0)
    v_cmp_ge_u32 vcc, 128, v61
    s_nop 1
    v_cndmask_b32 v90, 0, v90, vcc
    v_mov_b32 v126, v61
    v_max_u32 v58, 1024, v58
    v_cvt_f32_u32 v58, v58
    v_mul_f32 v59, 0x3f8147ae, v59
    v_max_f32 v59, 0x12800000, v59
    v_mul_f32 v58, v58, v59
    v_mul_f32 v65, 0x30029cbc, v58
    v_rcp_f32 v64, v65
    s_cmp_ge_u32 s5, 8
    s_cbranch_scc1 L_pr_t_21
L_pr_r_20:
    v_and_b32 v14, 0xffff, v80
    v_lshrrev_b32 v17, 16, v80
    v_lshlrev_b32 v14, 2, v14
    v_add_u32 v14, v14, v4
    s_mov_b32 s6, 0
    v_cmp_lt_u32 vcc, v5, v17
    s_mov_b64 exec, vcc
    buffer_load_dwordx3 v[14:16], v14, s[12:15], s6 offen
    s_mov_b64 exec, -1
    v_and_b32 v18, 0xffff, v81
    v_lshrrev_b32 v21, 16, v81
    v_lshlrev_b32 v18, 2, v18
    v_add_u32 v18, v18, v4
    s_mov_b32 s6, 6881280
    v_cmp_lt_u32 vcc, v5, v21
    s_mov_b64 exec, vcc
    buffer_load_dwordx3 v[18:20], v18, s[12:15], s6 offen
    s_mov_b64 exec, -1
    v_and_b32 v22, 0xffff, v82
    v_lshrrev_b32 v25, 16, v82
    v_lshlrev_b32 v22, 2, v22
    v_add_u32 v22, v22, v4
    s_mov_b32 s6, 13762560
    v_cmp_lt_u32 vcc, v5, v25
    s_mov_b64 exec, vcc
    buffer_load_dwordx3 v[22:24], v22, s[12:15], s6 offen
    s_mov_b64 exec, -1
    v_and_b32 v26, 0xffff, v83
    v_lshrrev_b32 v29, 16, v83
    v_lshlrev_b32 v26, 2, v26
    v_add_u32 v26, v26, v4
    s_mov_b32 s6, 20643840
    v_cmp_lt_u32 vcc, v5, v29
    s_mov_b64 exec, vcc
    buffer_load_dwordx3 v[26:28], v26, s[12:15], s6 offen
    s_mov_b64 exec, -1
    v_and_b32 v30, 0xffff, v84
    v_lshrrev_b32 v33, 16, v84
    v_lshlrev_b32 v30, 2, v30
    v_add_u32 v30, v30, v4
    s_mov_b32 s6, 27525120
    v_cmp_lt_u32 vcc, v5, v33
    s_mov_b64 exec, vcc
    buffer_load_dwordx3 v[30:32], v30, s[12:15], s6 offen
    s_mov_b64 exec, -1
    v_and_b32 v34, 0xffff, v85
    v_lshrrev_b32 v37, 16, v85
    v_lshlrev_b32 v34, 2, v34
    v_add_u32 v34, v34, v4
    s_mov_b32 s6, 34406400
    v_cmp_lt_u32 vcc, v5, v37
    s_mov_b64 exec, vcc
    buffer_load_dwordx3 v[34:36], v34, s[12:15], s6 offen
    s_mov_b64 exec, -1
    v_and_b32 v38, 0xffff, v86
    v_lshrrev_b32 v41, 16, v86
    v_lshlrev_b32 v38, 2, v38
    v_add_u32 v38, v38, v4
    s_mov_b32 s6, 41287680
    v_cmp_lt_u32 vcc, v5, v41
    s_mov_b64 exec, vcc
    buffer_load_dwordx3 v[38:40], v38, s[12:15], s6 offen
    s_mov_b64 exec, -1
    v_and_b32 v42, 0xffff, v87
    v_lshrrev_b32 v45, 16, v87
    v_lshlrev_b32 v42, 2, v42
    v_add_u32 v42, v42, v4
    s_mov_b32 s6, 48168960
    v_cmp_lt_u32 vcc, v5, v45
    s_mov_b64 exec, vcc
    buffer_load_dwordx3 v[42:44], v42, s[12:15], s6 offen
    s_mov_b64 exec, -1
    v_and_b32 v46, 0xffff, v88
    v_lshrrev_b32 v49, 16, v88
    v_lshlrev_b32 v46, 2, v46
    v_add_u32 v46, v46, v4
    s_mov_b32 s6, 55050240
    v_cmp_lt_u32 vcc, v5, v49
    s_mov_b64 exec, vcc
    buffer_load_dwordx3 v[46:48], v46, s[12:15], s6 offen
    s_mov_b64 exec, -1
    v_and_b32 v50, 0xffff, v89
    v_lshrrev_b32 v53, 16, v89
    v_lshlrev_b32 v50, 2, v50
    v_add_u32 v50, v50, v4
    s_mov_b32 s6, 61931520
    v_cmp_lt_u32 vcc, v5, v53
    s_mov_b64 exec, vcc
    buffer_load_dwordx3 v[50:52], v50, s[12:15], s6 offen
    s_mov_b64 exec, -1
    v_and_b32 v54, 0x1ffffff, v90
    v_lshrrev_b32 v57, 25, v90
    v_lshlrev_b32 v54, 2, v54
    v_mad_u32_u24 v54, v5, 6, v54
    s_mov_b32 s6, 0
    v_cmp_lt_u32 vcc, v5, v57
    s_mov_b64 exec, vcc
    buffer_load_dwordx3 v[54:56], v54, s[12:15], s6 offen
    s_mov_b64 exec, -1
    s_cmp_ge_u32 s5, 8
    s_cbranch_scc1 L_pr_d_22
L_pr_t_21:
    s_pack_ll_b32_b16 s4, s20, s26
    s_pack_hh_b32_b16 s26, s20, s26
    s_mov_b32 s20, s4
    s_pack_ll_b32_b16 s4, s21, s27
    s_pack_hh_b32_b16 s27, s21, s27
    s_mov_b32 s21, s4
    s_pack_ll_b32_b16 s4, s22, s28
    s_pack_hh_b32_b16 s28, s22, s28
    s_mov_b32 s22, s4
    s_pack_ll_b32_b16 s4, s23, s29
    s_pack_hh_b32_b16 s29, s23, s29
    s_mov_b32 s23, s4
    s_pack_ll_b32_b16 s4, s24, s30
    s_pack_hh_b32_b16 s30, s24, s30
    s_mov_b32 s24, s4
    s_pack_ll_b32_b16 s4, s25, s31
    s_pack_hh_b32_b16 s31, s25, s31
    s_mov_b32 s25, s4
    s_pack_ll_b32_b16 s4, s32, s38
    s_pack_hh_b32_b16 s38, s32, s38
    s_mov_b32 s32, s4
    s_pack_ll_b32_b16 s4, s33, s39
    s_pack_hh_b32_b16 s39, s33, s39
    s_mov_b32 s33, s4
    s_pack_ll_b32_b16 s4, s34, s40
    s_pack_hh_b32_b16 s40, s34, s40
    s_mov_b32 s34, s4
    s_pack_ll_b32_b16 s4, s35, s41
    s_pack_hh_b32_b16 s41, s35, s41
    s_mov_b32 s35, s4
    s_pack_ll_b32_b16 s4, s36, s42
    s_pack_hh_b32_b16 s42, s36, s42
    s_mov_b32 s36, s4
    s_pack_ll_b32_b16 s4, s37, s43
    s_pack_hh_b32_b16 s43, s37, s43
    s_mov_b32 s37, s4
    s_pack_ll_b32_b16 s4, s44, s50
    s_pack_hh_b32_b16 s50, s44, s50
    s_mov_b32 s44, s4
    s_pack_ll_b32_b16 s4, s45, s51
    s_pack_hh_b32_b16 s51, s45, s51
    s_mov_b32 s45, s4
    s_pack_ll_b32_b16 s4, s46, s52
    s_pack_hh_b32_b16 s52, s46, s52
    s_mov_b32 s46, s4
    s_pack_ll_b32_b16 s4, s47, s53
    s_pack_hh_b32_b16 s53, s47, s53
    s_mov_b32 s47, s4
    s_pack_ll_b32_b16 s4, s48, s54
    s_pack_hh_b32_b16 s54, s48, s54
    s_mov_b32 s48, s4
    s_pack_ll_b32_b16 s4, s49, s55
    s_pack_hh_b32_b16 s55, s49, s55
    s_mov_b32 s49, s4
    s_pack_ll_b32_b16 s4, s56, s62
    s_pack_hh_b32_b16 s62, s56, s62
    s_mov_b32 s56, s4
    s_pack_ll_b32_b16 s4, s57, s63
    s_pack_hh_b32_b16 s63, s57, s63
    s_mov_b32 s57, s4
    s_pack_ll_b32_b16 s4, s58, s64
    s_pack_hh_b32_b16 s64, s58, s64
    s_mov_b32 s58, s4
    s_pack_ll_b32_b16 s4, s59, s65
    s_pack_hh_b32_b16 s65, s59, s65
    s_mov_b32 s59, s4
    s_pack_ll_b32_b16 s4, s60, s66
    s_pack_hh_b32_b16 s66, s60, s66
    s_mov_b32 s60, s4
    s_pack_ll_b32_b16 s4, s61, s67
    s_pack_hh_b32_b16 s67, s61, s67
    s_mov_b32 s61, s4
    s_pack_ll_b32_b16 s4, s68, s70
    s_pack_hh_b32_b16 s70, s68, s70
    s_mov_b32 s68, s4
    s_pack_ll_b32_b16 s4, s69, s71
    s_pack_hh_b32_b16 s71, s69, s71
    s_mov_b32 s69, s4
    s_pack_ll_b32_b16 s4, s72, s74
    s_pack_hh_b32_b16 s74, s72, s74
    s_mov_b32 s72, s4
    s_pack_ll_b32_b16 s4, s73, s75
    s_pack_hh_b32_b16 s75, s73, s75
    s_mov_b32 s73, s4
    s_pack_ll_b32_b16 s4, s76, s78
    s_pack_hh_b32_b16 s78, s76, s78
    s_mov_b32 s76, s4
    s_pack_ll_b32_b16 s4, s77, s79
    s_pack_hh_b32_b16 s79, s77, s79
    s_mov_b32 s77, s4
    s_pack_ll_b32_b16 s4, s80, s82
    s_pack_hh_b32_b16 s82, s80, s82
    s_mov_b32 s80, s4
    s_pack_ll_b32_b16 s4, s81, s83
    s_pack_hh_b32_b16 s83, s81, s83
    s_mov_b32 s81, s4
    s_lshl_b32 s84, s96, 16
    s_and_b32 s85, s96, 0xffff0000
    s_lshl_b32 s86, s97, 16
    s_and_b32 s87, s97, 0xffff0000
    s_lshl_b32 s88, s98, 16
    s_and_b32 s89, s98, 0xffff0000
    s_lshl_b32 s90, s99, 16
    s_and_b32 s91, s99, 0xffff0000
    v_lshlrev_b32 v66, 16, v62
    v_subrev_f32 v68, s84, v66
    v_subrev_f32 v69, s85, v66
    v_subrev_f32 v70, s86, v66
    v_subrev_f32 v71, s87, v66
    v_subrev_f32 v72, s88, v66
    v_subrev_f32 v73, s89, v66
    v_subrev_f32 v74, s90, v66
    v_subrev_f32 v75, s91, v66
    v_mul_f32 v68, v68, v68
    v_mul_f32 v69, v69, v69
    v_mul_f32 v70, v70, v70
    v_mul_f32 v71, v71, v71
    v_mul_f32 v72, v72, v72
    v_mul_f32 v73, v73, v73
    v_mul_f32 v74, v74, v74
    v_mul_f32 v75, v75, v75
    v_mul_f32 v68, 0xc166d4ca, v68
    v_mul_f32 v69, 0xc166d4ca, v69
    v_mul_f32 v70, 0xc166d4ca, v70
    v_mul_f32 v71, 0xc166d4ca, v71
    v_mul_f32 v72, 0xc166d4ca, v72
    v_mul_f32 v73, 0xc166d4ca, v73
    v_mul_f32 v74, 0xc166d4ca, v74
    v_mul_f32 v75, 0xc166d4ca, v75
    v_exp_f32 v68, v68
    v_exp_f32 v69, v69
    v_exp_f32 v70, v70
    v_exp_f32 v71, v71
    v_exp_f32 v72, v72
    v_exp_f32 v73, v73
    v_exp_f32 v74, v74
    v_exp_f32 v75, v75
    s_nop 0
    v_cvt_pk_bf16_f32 v76, v68, v69
    v_cvt_pk_bf16_f32 v77, v70, v71
    v_cvt_pk_bf16_f32 v78, v72, v73
    v_cvt_pk_bf16_f32 v79, v74, v75
    v_dot2_f32_bf16 v92, v76, s20, 0
    v_dot2_f32_bf16 v93, v76, s26, 0
    v_dot2_f32_bf16 v94, v76, s21, 0
    v_dot2_f32_bf16 v95, v76, s27, 0
    v_dot2_f32_bf16 v96, v76, s22, 0
    v_dot2_f32_bf16 v97, v76, s28, 0
    v_dot2_f32_bf16 v98, v76, s23, 0
    v_dot2_f32_bf16 v99, v76, s29, 0
    v_dot2_f32_bf16 v100, v76, s24, 0
    v_dot2_f32_bf16 v101, v76, s30, 0
    v_dot2_f32_bf16 v102, v76, s25, 0
    v_dot2_f32_bf16 v103, v76, s31, 0
    v_dot2_f32_bf16 v104, v76, s68, 0
    v_dot2_f32_bf16 v105, v76, s70, 0
    v_dot2_f32_bf16 v106, v76, s69, 0
    v_dot2_f32_bf16 v107, v76, s71, 0
    v_dot2_f32_bf16 v92, v77, s32, v92
    v_dot2_f32_bf16 v93, v77, s38, v93
    v_dot2_f32_bf16 v94, v77, s33, v94
    v_dot2_f32_bf16 v95, v77, s39, v95
    v_dot2_f32_bf16 v96, v77, s34, v96
    v_dot2_f32_bf16 v97, v77, s40, v97
    v_dot2_f32_bf16 v98, v77, s35, v98
    v_dot2_f32_bf16 v99, v77, s41, v99
    v_dot2_f32_bf16 v100, v77, s36, v100
    v_dot2_f32_bf16 v101, v77, s42, v101
    v_dot2_f32_bf16 v102, v77, s37, v102
    v_dot2_f32_bf16 v103, v77, s43, v103
    v_dot2_f32_bf16 v104, v77, s72, v104
    v_dot2_f32_bf16 v105, v77, s74, v105
    v_dot2_f32_bf16 v106, v77, s73, v106
    v_dot2_f32_bf16 v107, v77, s75, v107
    v_dot2_f32_bf16 v92, v78, s44, v92
    v_dot2_f32_bf16 v93, v78, s50, v93
    v_dot2_f32_bf16 v94, v78, s45, v94
    v_dot2_f32_bf16 v95, v78, s51, v95
    v_dot2_f32_bf16 v96, v78, s46, v96
    v_dot2_f32_bf16 v97, v78, s52, v97
    v_dot2_f32_bf16 v98, v78, s47, v98
    v_dot2_f32_bf16 v99, v78, s53, v99
    v_dot2_f32_bf16 v100, v78, s48, v100
    v_dot2_f32_bf16 v101, v78, s54, v101
    v_dot2_f32_bf16 v102, v78, s49, v102
    v_dot2_f32_bf16 v103, v78, s55, v103
    v_dot2_f32_bf16 v104, v78, s76, v104
    v_dot2_f32_bf16 v105, v78, s78, v105
    v_dot2_f32_bf16 v106, v78, s77, v106
    v_dot2_f32_bf16 v107, v78, s79, v107
    v_dot2_f32_bf16 v92, v79, s56, v92
    v_dot2_f32_bf16 v93, v79, s62, v93
    v_dot2_f32_bf16 v94, v79, s57, v94
    v_dot2_f32_bf16 v95, v79, s63, v95
    v_dot2_f32_bf16 v96, v79, s58, v96
    v_dot2_f32_bf16 v97, v79, s64, v97
    v_dot2_f32_bf16 v98, v79, s59, v98
    v_dot2_f32_bf16 v99, v79, s65, v99
    v_dot2_f32_bf16 v100, v79, s60, v100
    v_dot2_f32_bf16 v101, v79, s66, v101
    v_dot2_f32_bf16 v102, v79, s61, v102
    v_dot2_f32_bf16 v103, v79, s67, v103
    v_dot2_f32_bf16 v104, v79, s80, v104
    v_dot2_f32_bf16 v105, v79, s82, v105
    v_dot2_f32_bf16 v106, v79, s81, v106
    v_dot2_f32_bf16 v107, v79, s83, v107
    s_nop 2
    v_add_f32 v108, |v92|, |v96|
    v_add_f32 v109, |v93|, |v97|
    v_add_f32 v110, |v94|, |v98|
    v_add_f32 v111, |v95|, |v99|
    v_add_f32 v108, v108, |v100|
    v_add_f32 v109, v109, |v101|
    v_add_f32 v110, v110, |v102|
    v_add_f32 v111, v111, |v103|
    v_max_f32 v108, 0x03800000, v108
    v_max_f32 v109, 0x03800000, v109
    v_max_f32 v110, 0x03800000, v110
    v_max_f32 v111, 0x03800000, v111
    v_rcp_f32 v68, v108
    v_rcp_f32 v69, v109
    v_rcp_f32 v70, v110
    v_rcp_f32 v71, v111
    s_nop 0
    v_mul_f32 v68, v68, v64
    v_mul_f32 v69, v69, v64
    v_mul_f32 v70, v70, v64
    v_mul_f32 v71, v71, v64
    v_mul_f32 v108, v108, v65
    v_mul_f32 v109, v109, v65
    v_mul_f32 v110, v110, v65
    v_mul_f32 v111, v111, v65
    v_mul_f32 v92, v92, v68
    v_mul_f32 v93, v93, v69
    v_mul_f32 v94, v94, v70
    v_mul_f32 v95, v95, v71
    v_mul_f32 v96, v96, v68
    v_mul_f32 v97, v97, v69
    v_mul_f32 v98, v98, v70
    v_mul_f32 v99, v99, v71
    v_mul_f32 v100, v100, v68
    v_mul_f32 v101, v101, v69
    v_mul_f32 v102, v102, v70
    v_mul_f32 v103, v103, v71
    v_cvt_pk_bf16_f32 v112, v92, v96
    v_cvt_pk_bf16_f32 v113, v93, v97
    v_cvt_pk_bf16_f32 v114, v94, v98
    v_cvt_pk_bf16_f32 v115, v95, v99
    v_cvt_pk_bf16_f32 v116, v100, v101
    v_cvt_pk_bf16_f32 v117, v102, v103
    v_add_u32 v66, 29984, v3
    ds_write_b128 v66, v[112:115]
    v_lshlrev_b32 v67, 3, v0
    ds_write_b64 v67, v[116:117] offset:49984
    v_add_u32 v66, s7, v0
    v_lshlrev_b32 v66, 5, v66
    s_mov_b32 s6, 73154560
    buffer_store_dwordx4 v[108:111], v66, s[12:15], s6 offen
    buffer_store_dwordx4 v[104:107], v66, s[12:15], s6 offen offset:16
    v_cmp_gt_u32 vcc, 226, v0
    s_mov_b64 exec, vcc
    s_cbranch_execz L_e1skip_23
    v_lshlrev_b32 v66, 16, v63
    v_subrev_f32 v68, s84, v66
    v_subrev_f32 v69, s85, v66
    v_subrev_f32 v70, s86, v66
    v_subrev_f32 v71, s87, v66
    v_subrev_f32 v72, s88, v66
    v_subrev_f32 v73, s89, v66
    v_subrev_f32 v74, s90, v66
    v_subrev_f32 v75, s91, v66
    v_mul_f32 v68, v68, v68
    v_mul_f32 v69, v69, v69
    v_mul_f32 v70, v70, v70
    v_mul_f32 v71, v71, v71
    v_mul_f32 v72, v72, v72
    v_mul_f32 v73, v73, v73
    v_mul_f32 v74, v74, v74
    v_mul_f32 v75, v75, v75
    v_mul_f32 v68, 0xc166d4ca, v68
    v_mul_f32 v69, 0xc166d4ca, v69
    v_mul_f32 v70, 0xc166d4ca, v70
    v_mul_f32 v71, 0xc166d4ca, v71
    v_mul_f32 v72, 0xc166d4ca, v72
    v_mul_f32 v73, 0xc166d4ca, v73
    v_mul_f32 v74, 0xc166d4ca, v74
    v_mul_f32 v75, 0xc166d4ca, v75
    v_exp_f32 v68, v68
    v_exp_f32 v69, v69
    v_exp_f32 v70, v70
    v_exp_f32 v71, v71
    v_exp_f32 v72, v72
    v_exp_f32 v73, v73
    v_exp_f32 v74, v74
    v_exp_f32 v75, v75
    s_nop 0
    v_cvt_pk_bf16_f32 v76, v68, v69
    v_cvt_pk_bf16_f32 v77, v70, v71
    v_cvt_pk_bf16_f32 v78, v72, v73
    v_cvt_pk_bf16_f32 v79, v74, v75
    v_dot2_f32_bf16 v92, v76, s20, 0
    v_dot2_f32_bf16 v93, v76, s26, 0
    v_dot2_f32_bf16 v94, v76, s21, 0
    v_dot2_f32_bf16 v95, v76, s27, 0
    v_dot2_f32_bf16 v96, v76, s22, 0
    v_dot2_f32_bf16 v97, v76, s28, 0
    v_dot2_f32_bf16 v98, v76, s23, 0
    v_dot2_f32_bf16 v99, v76, s29, 0
    v_dot2_f32_bf16 v100, v76, s24, 0
    v_dot2_f32_bf16 v101, v76, s30, 0
    v_dot2_f32_bf16 v102, v76, s25, 0
    v_dot2_f32_bf16 v103, v76, s31, 0
    v_dot2_f32_bf16 v104, v76, s68, 0
    v_dot2_f32_bf16 v105, v76, s70, 0
    v_dot2_f32_bf16 v106, v76, s69, 0
    v_dot2_f32_bf16 v107, v76, s71, 0
    v_dot2_f32_bf16 v92, v77, s32, v92
    v_dot2_f32_bf16 v93, v77, s38, v93
    v_dot2_f32_bf16 v94, v77, s33, v94
    v_dot2_f32_bf16 v95, v77, s39, v95
    v_dot2_f32_bf16 v96, v77, s34, v96
    v_dot2_f32_bf16 v97, v77, s40, v97
    v_dot2_f32_bf16 v98, v77, s35, v98
    v_dot2_f32_bf16 v99, v77, s41, v99
    v_dot2_f32_bf16 v100, v77, s36, v100
    v_dot2_f32_bf16 v101, v77, s42, v101
    v_dot2_f32_bf16 v102, v77, s37, v102
    v_dot2_f32_bf16 v103, v77, s43, v103
    v_dot2_f32_bf16 v104, v77, s72, v104
    v_dot2_f32_bf16 v105, v77, s74, v105
    v_dot2_f32_bf16 v106, v77, s73, v106
    v_dot2_f32_bf16 v107, v77, s75, v107
    v_dot2_f32_bf16 v92, v78, s44, v92
    v_dot2_f32_bf16 v93, v78, s50, v93
    v_dot2_f32_bf16 v94, v78, s45, v94
    v_dot2_f32_bf16 v95, v78, s51, v95
    v_dot2_f32_bf16 v96, v78, s46, v96
    v_dot2_f32_bf16 v97, v78, s52, v97
    v_dot2_f32_bf16 v98, v78, s47, v98
    v_dot2_f32_bf16 v99, v78, s53, v99
    v_dot2_f32_bf16 v100, v78, s48, v100
    v_dot2_f32_bf16 v101, v78, s54, v101
    v_dot2_f32_bf16 v102, v78, s49, v102
    v_dot2_f32_bf16 v103, v78, s55, v103
    v_dot2_f32_bf16 v104, v78, s76, v104
    v_dot2_f32_bf16 v105, v78, s78, v105
    v_dot2_f32_bf16 v106, v78, s77, v106
    v_dot2_f32_bf16 v107, v78, s79, v107
    v_dot2_f32_bf16 v92, v79, s56, v92
    v_dot2_f32_bf16 v93, v79, s62, v93
    v_dot2_f32_bf16 v94, v79, s57, v94
    v_dot2_f32_bf16 v95, v79, s63, v95
    v_dot2_f32_bf16 v96, v79, s58, v96
    v_dot2_f32_bf16 v97, v79, s64, v97
    v_dot2_f32_bf16 v98, v79, s59, v98
    v_dot2_f32_bf16 v99, v79, s65, v99
    v_dot2_f32_bf16 v100, v79, s60, v100
    v_dot2_f32_bf16 v101, v79, s66, v101
    v_dot2_f32_bf16 v102, v79, s61, v102
    v_dot2_f32_bf16 v103, v79, s67, v103
    v_dot2_f32_bf16 v104, v79, s80, v104
    v_dot2_f32_bf16 v105, v79, s82, v105
    v_dot2_f32_bf16 v106, v79, s81, v106
    v_dot2_f32_bf16 v107, v79, s83, v107
    s_nop 2
    v_add_f32 v108, |v92|, |v96|
    v_add_f32 v109, |v93|, |v97|
    v_add_f32 v110, |v94|, |v98|
    v_add_f32 v111, |v95|, |v99|
    v_add_f32 v108, v108, |v100|
    v_add_f32 v109, v109, |v101|
    v_add_f32 v110, v110, |v102|
    v_add_f32 v111, v111, |v103|
    v_max_f32 v108, 0x03800000, v108
    v_max_f32 v109, 0x03800000, v109
    v_max_f32 v110, 0x03800000, v110
    v_max_f32 v111, 0x03800000, v111
    v_rcp_f32 v68, v108
    v_rcp_f32 v69, v109
    v_rcp_f32 v70, v110
    v_rcp_f32 v71, v111
    s_nop 0
    v_mul_f32 v68, v68, v64
    v_mul_f32 v69, v69, v64
    v_mul_f32 v70, v70, v64
    v_mul_f32 v71, v71, v64
    v_mul_f32 v108, v108, v65
    v_mul_f32 v109, v109, v65
    v_mul_f32 v110, v110, v65
    v_mul_f32 v111, v111, v65
    v_mul_f32 v92, v92, v68
    v_mul_f32 v93, v93, v69
    v_mul_f32 v94, v94, v70
    v_mul_f32 v95, v95, v71
    v_mul_f32 v96, v96, v68
    v_mul_f32 v97, v97, v69
    v_mul_f32 v98, v98, v70
    v_mul_f32 v99, v99, v71
    v_mul_f32 v100, v100, v68
    v_mul_f32 v101, v101, v69
    v_mul_f32 v102, v102, v70
    v_mul_f32 v103, v103, v71
    v_cvt_pk_bf16_f32 v112, v92, v96
    v_cvt_pk_bf16_f32 v113, v93, v97
    v_cvt_pk_bf16_f32 v114, v94, v98
    v_cvt_pk_bf16_f32 v115, v95, v99
    v_cvt_pk_bf16_f32 v116, v100, v101
    v_cvt_pk_bf16_f32 v117, v102, v103
    v_add_u32 v66, 46368, v3
    ds_write_b128 v66, v[112:115]
    v_lshlrev_b32 v67, 3, v0
    ds_write_b64 v67, v[116:117] offset:58176
    v_add_u32 v66, s7, v0
    v_lshlrev_b32 v66, 5, v66
    s_mov_b32 s6, 73187328
    buffer_store_dwordx4 v[108:111], v66, s[12:15], s6 offen
    buffer_store_dwordx4 v[104:107], v66, s[12:15], s6 offen offset:16
L_e1skip_23:
    s_mov_b64 exec, -1
    s_cmp_ge_u32 s5, 8
    s_cbranch_scc1 L_pr_r_20
L_pr_d_22:
    s_add_u32 s88, s12, 83394560
    s_addc_u32 s89, s13, 0
    s_mov_b32 s16, s88
    s_and_b32 s17, s89, 0xffff
    s_or_b32 s17, s17, 0x80000
    s_mov_b32 s18, 320000
    s_mov_b32 s19, 0x00020000
    v_readfirstlane_b32 s86, v126
    s_mov_b32 s80, 0
    s_mov_b32 s81, 0
    s_mov_b32 s85, 0
    s_and_b32 s87, s3, 1
L_HS_24:
    s_mov_b32 s82, 0
    s_mov_b32 s79, 0
    s_cmp_eq_u32 s80, 1
    s_cselect_b32 s82, 0xfffff2fc, s82
    s_cselect_b32 s79, 106656, s79
    s_cmp_eq_u32 s80, 2
    s_cselect_b32 s82, 0xffffe5f8, s82
    s_cselect_b32 s79, 213328, s79
    s_cmp_gt_u32 s86, 128
    s_cselect_b32 s78, 16, 0
    s_lshl_b32 s78, s78, s80
    s_or_b32 s85, s85, s78
    v_cmp_lt_u32 s[32:33], v5, v17
    v_cmp_lt_u32 s[54:55], v6, v17
    v_cmp_lt_u32 s[34:35], v5, v21
    v_cmp_lt_u32 s[56:57], v6, v21
    v_cmp_lt_u32 s[36:37], v5, v25
    v_cmp_lt_u32 s[58:59], v6, v25
    v_cmp_lt_u32 s[38:39], v5, v29
    v_cmp_lt_u32 s[60:61], v6, v29
    v_cmp_lt_u32 s[40:41], v5, v33
    v_cmp_lt_u32 s[62:63], v6, v33
    v_cmp_lt_u32 s[42:43], v5, v37
    v_cmp_lt_u32 s[64:65], v6, v37
    v_cmp_lt_u32 s[44:45], v5, v41
    v_cmp_lt_u32 s[66:67], v6, v41
    v_cmp_lt_u32 s[46:47], v5, v45
    v_cmp_lt_u32 s[68:69], v6, v45
    v_cmp_lt_u32 s[48:49], v5, v49
    v_cmp_lt_u32 s[70:71], v6, v49
    v_cmp_lt_u32 s[50:51], v5, v53
    v_cmp_lt_u32 s[72:73], v6, v53
    v_cmp_lt_u32 s[52:53], v5, v57
    v_cmp_lt_u32 s[74:75], v6, v57
    s_waitcnt vmcnt(0)
    v_bfe_u32 v92, v14, 7, 12
    v_lshl_add_u32 v92, v92, 2, s82
    v_bfe_u32 v93, v15, 7, 12
    v_lshl_add_u32 v93, v93, 2, s82
    s_mov_b64 exec, s[32:33]
    ds_add_rtn_u32 v17, v92, v9 offset:0
    s_mov_b64 exec, s[54:55]
    ds_add_rtn_u32 v112, v93, v9 offset:0
    s_mov_b64 exec, -1
    v_bfe_u32 v94, v18, 7, 12
    v_lshl_add_u32 v94, v94, 2, s82
    v_bfe_u32 v95, v19, 7, 12
    v_lshl_add_u32 v95, v95, 2, s82
    s_mov_b64 exec, s[34:35]
    ds_add_rtn_u32 v21, v94, v9 offset:0
    s_mov_b64 exec, s[56:57]
    ds_add_rtn_u32 v113, v95, v9 offset:0
    s_mov_b64 exec, -1
    v_bfe_u32 v92, v22, 7, 12
    v_lshl_add_u32 v92, v92, 2, s82
    v_bfe_u32 v93, v23, 7, 12
    v_lshl_add_u32 v93, v93, 2, s82
    s_mov_b64 exec, s[36:37]
    ds_add_rtn_u32 v25, v92, v9 offset:0
    s_mov_b64 exec, s[58:59]
    ds_add_rtn_u32 v114, v93, v9 offset:0
    s_mov_b64 exec, -1
    v_bfe_u32 v94, v26, 7, 12
    v_lshl_add_u32 v94, v94, 2, s82
    v_bfe_u32 v95, v27, 7, 12
    v_lshl_add_u32 v95, v95, 2, s82
    s_mov_b64 exec, s[38:39]
    ds_add_rtn_u32 v29, v94, v9 offset:0
    s_mov_b64 exec, s[60:61]
    ds_add_rtn_u32 v115, v95, v9 offset:0
    s_mov_b64 exec, -1
    v_bfe_u32 v92, v30, 7, 12
    v_lshl_add_u32 v92, v92, 2, s82
    v_bfe_u32 v93, v31, 7, 12
    v_lshl_add_u32 v93, v93, 2, s82
    s_mov_b64 exec, s[40:41]
    ds_add_rtn_u32 v33, v92, v9 offset:0
    s_mov_b64 exec, s[62:63]
    ds_add_rtn_u32 v116, v93, v9 offset:0
    s_mov_b64 exec, -1
    v_bfe_u32 v94, v34, 7, 12
    v_lshl_add_u32 v94, v94, 2, s82
    v_bfe_u32 v95, v35, 7, 12
    v_lshl_add_u32 v95, v95, 2, s82
    s_mov_b64 exec, s[42:43]
    ds_add_rtn_u32 v37, v94, v9 offset:0
    s_mov_b64 exec, s[64:65]
    ds_add_rtn_u32 v117, v95, v9 offset:0
    s_mov_b64 exec, -1
    v_bfe_u32 v92, v38, 7, 12
    v_lshl_add_u32 v92, v92, 2, s82
    v_bfe_u32 v93, v39, 7, 12
    v_lshl_add_u32 v93, v93, 2, s82
    s_mov_b64 exec, s[44:45]
    ds_add_rtn_u32 v41, v92, v9 offset:0
    s_mov_b64 exec, s[66:67]
    ds_add_rtn_u32 v118, v93, v9 offset:0
    s_mov_b64 exec, -1
    v_bfe_u32 v94, v42, 7, 12
    v_lshl_add_u32 v94, v94, 2, s82
    v_bfe_u32 v95, v43, 7, 12
    v_lshl_add_u32 v95, v95, 2, s82
    s_mov_b64 exec, s[46:47]
    ds_add_rtn_u32 v45, v94, v9 offset:0
    s_mov_b64 exec, s[68:69]
    ds_add_rtn_u32 v119, v95, v9 offset:0
    s_mov_b64 exec, -1
    v_bfe_u32 v92, v46, 7, 12
    v_lshl_add_u32 v92, v92, 2, s82
    v_bfe_u32 v93, v47, 7, 12
    v_lshl_add_u32 v93, v93, 2, s82
    s_mov_b64 exec, s[48:49]
    ds_add_rtn_u32 v49, v92, v9 offset:0
    s_mov_b64 exec, s[70:71]
    ds_add_rtn_u32 v120, v93, v9 offset:0
    s_mov_b64 exec, -1
    v_bfe_u32 v94, v50, 7, 12
    v_lshl_add_u32 v94, v94, 2, s82
    v_bfe_u32 v95, v51, 7, 12
    v_lshl_add_u32 v95, v95, 2, s82
    s_mov_b64 exec, s[50:51]
    ds_add_rtn_u32 v53, v94, v9 offset:0
    s_mov_b64 exec, s[72:73]
    ds_add_rtn_u32 v121, v95, v9 offset:0
    s_mov_b64 exec, -1
    s_cmp_eq_u64 s[52:53], 0
    s_cbranch_scc1 L_hx_28
    v_bfe_u32 v96, v54, 7, 12
    v_lshl_add_u32 v96, v96, 2, s82
    v_bfe_u32 v97, v55, 7, 12
    v_lshl_add_u32 v97, v97, 2, s82
    s_mov_b64 exec, s[52:53]
    ds_add_rtn_u32 v57, v96, v9 offset:0
    s_mov_b64 exec, s[74:75]
    ds_add_rtn_u32 v122, v97, v9 offset:0
    s_mov_b64 exec, -1
L_hx_28:
    s_waitcnt lgkmcnt(0)
    s_barrier
    s_cmp_lg_u32 s5, 0
    s_cbranch_scc1 L_scanskip_29
    v_lshlrev_b32 v84, 6, v2
    ds_read_b128 v[92:95], v84 offset:0
    ds_read_b128 v[96:99], v84 offset:16
    ds_read_b128 v[100:103], v84 offset:32
    ds_read_b128 v[104:107], v84 offset:48
    v_mov_b32 v80, 0
    v_mov_b32 v81, 0
    v_mov_b32 v82, 0
    v_mov_b32 v83, 0
    s_waitcnt lgkmcnt(0)
    ds_write_b128 v84, v[80:83] offset:0
    ds_write_b128 v84, v[80:83] offset:16
    ds_write_b128 v84, v[80:83] offset:32
    ds_write_b128 v84, v[80:83] offset:48
    v_mov_b32 v85, v92
    v_mov_b32 v86, v93
    v_mov_b32 v93, v85
    v_add_u32 v85, v85, v86
    v_mov_b32 v86, v94
    v_mov_b32 v94, v85
    v_add_u32 v85, v85, v86
    v_mov_b32 v86, v95
    v_mov_b32 v95, v85
    v_add_u32 v85, v85, v86
    v_mov_b32 v86, v96
    v_mov_b32 v96, v85
    v_add_u32 v85, v85, v86
    v_mov_b32 v86, v97
    v_mov_b32 v97, v85
    v_add_u32 v85, v85, v86
    v_mov_b32 v86, v98
    v_mov_b32 v98, v85
    v_add_u32 v85, v85, v86
    v_mov_b32 v86, v99
    v_mov_b32 v99, v85
    v_add_u32 v85, v85, v86
    v_mov_b32 v86, v100
    v_mov_b32 v100, v85
    v_add_u32 v85, v85, v86
    v_mov_b32 v86, v101
    v_mov_b32 v101, v85
    v_add_u32 v85, v85, v86
    v_mov_b32 v86, v102
    v_mov_b32 v102, v85
    v_add_u32 v85, v85, v86
    v_mov_b32 v86, v103
    v_mov_b32 v103, v85
    v_add_u32 v85, v85, v86
    v_mov_b32 v86, v104
    v_mov_b32 v104, v85
    v_add_u32 v85, v85, v86
    v_mov_b32 v86, v105
    v_mov_b32 v105, v85
    v_add_u32 v85, v85, v86
    v_mov_b32 v86, v106
    v_mov_b32 v106, v85
    v_add_u32 v85, v85, v86
    v_mov_b32 v86, v107
    v_mov_b32 v107, v85
    v_add_u32 v85, v85, v86
    v_mov_b32 v92, 0
    v_mov_b32 v86, v85
    s_nop 1
    v_add_u32_dpp v86, v86, v86 row_shr:1 row_mask:0xf bank_mask:0xf bound_ctrl:0
    s_nop 1
    v_add_u32_dpp v86, v86, v86 row_shr:2 row_mask:0xf bank_mask:0xf bound_ctrl:0
    s_nop 1
    v_add_u32_dpp v86, v86, v86 row_shr:4 row_mask:0xf bank_mask:0xf bound_ctrl:0
    s_nop 1
    v_add_u32_dpp v86, v86, v86 row_shr:8 row_mask:0xf bank_mask:0xf bound_ctrl:0
    s_nop 1
    v_add_u32_dpp v86, v86, v86 row_bcast:15 row_mask:0xa bank_mask:0xf
    s_nop 1
    v_add_u32_dpp v86, v86, v86 row_bcast:31 row_mask:0xc bank_mask:0xf
    s_nop 1
    v_sub_u32 v87, v86, v85
    v_add_u32 v87, 132688, v87
    v_add_u32 v92, v92, v87
    v_add_u32 v93, v93, v87
    v_add_u32 v94, v94, v87
    v_add_u32 v95, v95, v87
    v_add_u32 v96, v96, v87
    v_add_u32 v97, v97, v87
    v_add_u32 v98, v98, v87
    v_add_u32 v99, v99, v87
    v_add_u32 v100, v100, v87
    v_add_u32 v101, v101, v87
    v_add_u32 v102, v102, v87
    v_add_u32 v103, v103, v87
    v_add_u32 v104, v104, v87
    v_add_u32 v105, v105, v87
    v_add_u32 v106, v106, v87
    v_add_u32 v107, v107, v87
    ds_write_b128 v84, v[92:95] offset:4096
    ds_write_b128 v84, v[96:99] offset:4112
    ds_write_b128 v84, v[100:103] offset:4128
    ds_write_b128 v84, v[104:107] offset:4144
    v_mov_b32 v84, 8192
    s_mov_b32 exec_lo, 0
    s_mov_b32 exec_hi, 0x80000000
    ds_write_b32 v84, v86 offset:8
    s_mov_b64 exec, -1
    s_waitcnt lgkmcnt(0)
L_scanskip_29:
    s_barrier
    s_add_u32 s79, s80, 1
    s_cmp_lt_u32 s79, 3
    s_cselect_b64 s[76:77], -1, 0
    s_min_u32 s79, s79, 2
    s_lshl_b32 s88, s79, 2
    s_lshl_b32 s89, s79, 9
    v_add_u32 v13, s88, v8
    v_lshrrev_b32 v108, 3, v0
    v_lshlrev_b32 v108, 2, v108
    v_add_u32 v108, s89, v108
    v_add_u32 v108, 8448, v108
    v_mov_b32 v109, 8192
    ds_read_b32 v110, v109 offset:8
    v_add_u32 v109, s88, v109
    ds_read_b32 v111, v109 offset:16
    ds_read_b32 v80, v13 offset:0
    ds_read_b32 v81, v13 offset:1536
    ds_read_b32 v82, v13 offset:3072
    ds_read_b32 v83, v13 offset:4608
    ds_read_b32 v84, v13 offset:6144
    ds_read_b32 v85, v13 offset:7680
    ds_read_b32 v86, v13 offset:9216
    ds_read_b32 v87, v13 offset:10752
    ds_read_b32 v88, v13 offset:12288
    ds_read_b32 v89, v13 offset:13824
    ds_read_b32 v90, v108
    s_waitcnt lgkmcnt(0)
    v_lshrrev_b32 v110, 1, v110
    v_cmp_ge_u32 vcc, 128, v111
    s_nop 1
    v_readfirstlane_b32 s83, v110
    v_readfirstlane_b32 s86, v111
    v_cndmask_b32 v90, 0, v90, vcc
    s_nop 2
    s_cmp_gt_u32 s83, 14336
    s_cbranch_scc1 L_noscat_30
    s_mov_b32 s89, 0xfffd19b0
    v_bfe_u32 v92, v14, 7, 12
    v_lshl_add_u32 v92, v92, 2, s82
    v_bfe_u32 v93, v15, 7, 12
    v_lshl_add_u32 v93, v93, 2, s82
    s_mov_b64 exec, s[32:33]
    ds_read_b32 v92, v92 offset:4096
    s_mov_b64 exec, s[54:55]
    ds_read_b32 v93, v93 offset:4096
    s_mov_b64 exec, -1
    v_bfe_u32 v96, v18, 7, 12
    v_lshl_add_u32 v96, v96, 2, s82
    v_bfe_u32 v97, v19, 7, 12
    v_lshl_add_u32 v97, v97, 2, s82
    s_mov_b64 exec, s[34:35]
    ds_read_b32 v96, v96 offset:4096
    s_mov_b64 exec, s[56:57]
    ds_read_b32 v97, v97 offset:4096
    s_mov_b64 exec, -1
    v_bfe_u32 v100, v22, 7, 12
    v_lshl_add_u32 v100, v100, 2, s82
    v_bfe_u32 v101, v23, 7, 12
    v_lshl_add_u32 v101, v101, 2, s82
    s_mov_b64 exec, s[36:37]
    ds_read_b32 v100, v100 offset:4096
    s_mov_b64 exec, s[58:59]
    ds_read_b32 v101, v101 offset:4096
    s_mov_b64 exec, -1
    s_waitcnt lgkmcnt(4)
    v_add_u32 v92, v92, v17
    v_add_u32 v93, v93, v112
    v_lshl_add_u32 v94, v92, 1, s89
    v_lshl_add_u32 v95, v93, 1, s89
    s_mov_b64 exec, s[32:33]
    ds_write_b32 v94, v14
    ds_write_b16 v92, v16
    s_mov_b64 exec, s[54:55]
    ds_write_b32 v95, v15
    ds_write_b16_d16_hi v93, v16
    s_mov_b64 exec, -1
    v_bfe_u32 v104, v26, 7, 12
    v_lshl_add_u32 v104, v104, 2, s82
    v_bfe_u32 v105, v27, 7, 12
    v_lshl_add_u32 v105, v105, 2, s82
    s_mov_b64 exec, s[38:39]
    ds_read_b32 v104, v104 offset:4096
    s_mov_b64 exec, s[60:61]
    ds_read_b32 v105, v105 offset:4096
    s_mov_b64 exec, -1
    s_waitcnt lgkmcnt(8)
    v_add_u32 v96, v96, v21
    v_add_u32 v97, v97, v113
    v_lshl_add_u32 v98, v96, 1, s89
    v_lshl_add_u32 v99, v97, 1, s89
    s_mov_b64 exec, s[34:35]
    ds_write_b32 v98, v18
    ds_write_b16 v96, v20
    s_mov_b64 exec, s[56:57]
    ds_write_b32 v99, v19
    ds_write_b16_d16_hi v97, v20
    s_mov_b64 exec, -1
    v_and_b32 v14, 0xffff, v80
    v_lshrrev_b32 v17, 16, v80
    v_lshlrev_b32 v14, 2, v14
    v_add_u32 v14, v14, v4
    s_mov_b32 s88, 0
    v_cmp_lt_u32 vcc, v5, v17
    s_and_b64 exec, vcc, s[76:77]
    buffer_load_dwordx3 v[14:16], v14, s[12:15], s88 offen
    s_mov_b64 exec, -1
    v_bfe_u32 v92, v30, 7, 12
    v_lshl_add_u32 v92, v92, 2, s82
    v_bfe_u32 v93, v31, 7, 12
    v_lshl_add_u32 v93, v93, 2, s82
    s_mov_b64 exec, s[40:41]
    ds_read_b32 v92, v92 offset:4096
    s_mov_b64 exec, s[62:63]
    ds_read_b32 v93, v93 offset:4096
    s_mov_b64 exec, -1
    s_waitcnt lgkmcnt(8)
    v_add_u32 v100, v100, v25
    v_add_u32 v101, v101, v114
    v_lshl_add_u32 v102, v100, 1, s89
    v_lshl_add_u32 v103, v101, 1, s89
    s_mov_b64 exec, s[36:37]
    ds_write_b32 v102, v22
    ds_write_b16 v100, v24
    s_mov_b64 exec, s[58:59]
    ds_write_b32 v103, v23
    ds_write_b16_d16_hi v101, v24
    s_mov_b64 exec, -1
    v_and_b32 v18, 0xffff, v81
    v_lshrrev_b32 v21, 16, v81
    v_lshlrev_b32 v18, 2, v18
    v_add_u32 v18, v18, v4
    s_mov_b32 s88, 6881280
    v_cmp_lt_u32 vcc, v5, v21
    s_and_b64 exec, vcc, s[76:77]
    buffer_load_dwordx3 v[18:20], v18, s[12:15], s88 offen
    s_mov_b64 exec, -1
    v_bfe_u32 v96, v34, 7, 12
    v_lshl_add_u32 v96, v96, 2, s82
    v_bfe_u32 v97, v35, 7, 12
    v_lshl_add_u32 v97, v97, 2, s82
    s_mov_b64 exec, s[42:43]
    ds_read_b32 v96, v96 offset:4096
    s_mov_b64 exec, s[64:65]
    ds_read_b32 v97, v97 offset:4096
    s_mov_b64 exec, -1
    s_waitcnt lgkmcnt(8)
    v_add_u32 v104, v104, v29
    v_add_u32 v105, v105, v115
    v_lshl_add_u32 v106, v104, 1, s89
    v_lshl_add_u32 v107, v105, 1, s89
    s_mov_b64 exec, s[38:39]
    ds_write_b32 v106, v26
    ds_write_b16 v104, v28
    s_mov_b64 exec, s[60:61]
    ds_write_b32 v107, v27
    ds_write_b16_d16_hi v105, v28
    s_mov_b64 exec, -1
    v_and_b32 v22, 0xffff, v82
    v_lshrrev_b32 v25, 16, v82
    v_lshlrev_b32 v22, 2, v22
    v_add_u32 v22, v22, v4
    s_mov_b32 s88, 13762560
    v_cmp_lt_u32 vcc, v5, v25
    s_and_b64 exec, vcc, s[76:77]
    buffer_load_dwordx3 v[22:24], v22, s[12:15], s88 offen
    s_mov_b64 exec, -1
    v_bfe_u32 v100, v38, 7, 12
    v_lshl_add_u32 v100, v100, 2, s82
    v_bfe_u32 v101, v39, 7, 12
    v_lshl_add_u32 v101, v101, 2, s82
    s_mov_b64 exec, s[44:45]
    ds_read_b32 v100, v100 offset:4096
    s_mov_b64 exec, s[66:67]
    ds_read_b32 v101, v101 offset:4096
    s_mov_b64 exec, -1
    s_waitcnt lgkmcnt(8)
    v_add_u32 v92, v92, v33
    v_add_u32 v93, v93, v116
    v_lshl_add_u32 v94, v92, 1, s89
    v_lshl_add_u32 v95, v93, 1, s89
    s_mov_b64 exec, s[40:41]
    ds_write_b32 v94, v30
    ds_write_b16 v92, v32
    s_mov_b64 exec, s[62:63]
    ds_write_b32 v95, v31
    ds_write_b16_d16_hi v93, v32
    s_mov_b64 exec, -1
    v_and_b32 v26, 0xffff, v83
    v_lshrrev_b32 v29, 16, v83
    v_lshlrev_b32 v26, 2, v26
    v_add_u32 v26, v26, v4
    s_mov_b32 s88, 20643840
    v_cmp_lt_u32 vcc, v5, v29
    s_and_b64 exec, vcc, s[76:77]
    buffer_load_dwordx3 v[26:28], v26, s[12:15], s88 offen
    s_mov_b64 exec, -1
    v_bfe_u32 v104, v42, 7, 12
    v_lshl_add_u32 v104, v104, 2, s82
    v_bfe_u32 v105, v43, 7, 12
    v_lshl_add_u32 v105, v105, 2, s82
    s_mov_b64 exec, s[46:47]
    ds_read_b32 v104, v104 offset:4096
    s_mov_b64 exec, s[68:69]
    ds_read_b32 v105, v105 offset:4096
    s_mov_b64 exec, -1
    s_waitcnt lgkmcnt(8)
    v_add_u32 v96, v96, v37
    v_add_u32 v97, v97, v117
    v_lshl_add_u32 v98, v96, 1, s89
    v_lshl_add_u32 v99, v97, 1, s89
    s_mov_b64 exec, s[42:43]
    ds_write_b32 v98, v34
    ds_write_b16 v96, v36
    s_mov_b64 exec, s[64:65]
    ds_write_b32 v99, v35
    ds_write_b16_d16_hi v97, v36
    s_mov_b64 exec, -1
    v_and_b32 v30, 0xffff, v84
    v_lshrrev_b32 v33, 16, v84
    v_lshlrev_b32 v30, 2, v30
    v_add_u32 v30, v30, v4
    s_mov_b32 s88, 27525120
    v_cmp_lt_u32 vcc, v5, v33
    s_and_b64 exec, vcc, s[76:77]
    buffer_load_dwordx3 v[30:32], v30, s[12:15], s88 offen
    s_mov_b64 exec, -1
    v_bfe_u32 v92, v46, 7, 12
    v_lshl_add_u32 v92, v92, 2, s82
    v_bfe_u32 v93, v47, 7, 12
    v_lshl_add_u32 v93, v93, 2, s82
    s_mov_b64 exec, s[48:49]
    ds_read_b32 v92, v92 offset:4096
    s_mov_b64 exec, s[70:71]
    ds_read_b32 v93, v93 offset:4096
    s_mov_b64 exec, -1
    s_waitcnt lgkmcnt(8)
    v_add_u32 v100, v100, v41
    v_add_u32 v101, v101, v118
    v_lshl_add_u32 v102, v100, 1, s89
    v_lshl_add_u32 v103, v101, 1, s89
    s_mov_b64 exec, s[44:45]
    ds_write_b32 v102, v38
    ds_write_b16 v100, v40
    s_mov_b64 exec, s[66:67]
    ds_write_b32 v103, v39
    ds_write_b16_d16_hi v101, v40
    s_mov_b64 exec, -1
    v_and_b32 v34, 0xffff, v85
    v_lshrrev_b32 v37, 16, v85
    v_lshlrev_b32 v34, 2, v34
    v_add_u32 v34, v34, v4
    s_mov_b32 s88, 34406400
    v_cmp_lt_u32 vcc, v5, v37
    s_and_b64 exec, vcc, s[76:77]
    buffer_load_dwordx3 v[34:36], v34, s[12:15], s88 offen
    s_mov_b64 exec, -1
    v_bfe_u32 v96, v50, 7, 12
    v_lshl_add_u32 v96, v96, 2, s82
    v_bfe_u32 v97, v51, 7, 12
    v_lshl_add_u32 v97, v97, 2, s82
    s_mov_b64 exec, s[50:51]
    ds_read_b32 v96, v96 offset:4096
    s_mov_b64 exec, s[72:73]
    ds_read_b32 v97, v97 offset:4096
    s_mov_b64 exec, -1
    s_waitcnt lgkmcnt(8)
    v_add_u32 v104, v104, v45
    v_add_u32 v105, v105, v119
    v_lshl_add_u32 v106, v104, 1, s89
    v_lshl_add_u32 v107, v105, 1, s89
    s_mov_b64 exec, s[46:47]
    ds_write_b32 v106, v42
    ds_write_b16 v104, v44
    s_mov_b64 exec, s[68:69]
    ds_write_b32 v107, v43
    ds_write_b16_d16_hi v105, v44
    s_mov_b64 exec, -1
    v_and_b32 v38, 0xffff, v86
    v_lshrrev_b32 v41, 16, v86
    v_lshlrev_b32 v38, 2, v38
    v_add_u32 v38, v38, v4
    s_mov_b32 s88, 41287680
    v_cmp_lt_u32 vcc, v5, v41
    s_and_b64 exec, vcc, s[76:77]
    buffer_load_dwordx3 v[38:40], v38, s[12:15], s88 offen
    s_mov_b64 exec, -1
    s_waitcnt lgkmcnt(0)
    v_add_u32 v92, v92, v49
    v_add_u32 v93, v93, v120
    v_lshl_add_u32 v94, v92, 1, s89
    v_lshl_add_u32 v95, v93, 1, s89
    s_mov_b64 exec, s[48:49]
    ds_write_b32 v94, v46
    ds_write_b16 v92, v48
    s_mov_b64 exec, s[70:71]
    ds_write_b32 v95, v47
    ds_write_b16_d16_hi v93, v48
    s_mov_b64 exec, -1
    v_and_b32 v42, 0xffff, v87
    v_lshrrev_b32 v45, 16, v87
    v_lshlrev_b32 v42, 2, v42
    v_add_u32 v42, v42, v4
    s_mov_b32 s88, 48168960
    v_cmp_lt_u32 vcc, v5, v45
    s_and_b64 exec, vcc, s[76:77]
    buffer_load_dwordx3 v[42:44], v42, s[12:15], s88 offen
    s_mov_b64 exec, -1
    v_add_u32 v96, v96, v53
    v_add_u32 v97, v97, v121
    v_lshl_add_u32 v98, v96, 1, s89
    v_lshl_add_u32 v99, v97, 1, s89
    s_mov_b64 exec, s[50:51]
    ds_write_b32 v98, v50
    ds_write_b16 v96, v52
    s_mov_b64 exec, s[72:73]
    ds_write_b32 v99, v51
    ds_write_b16_d16_hi v97, v52
    s_mov_b64 exec, -1
    v_and_b32 v46, 0xffff, v88
    v_lshrrev_b32 v49, 16, v88
    v_lshlrev_b32 v46, 2, v46
    v_add_u32 v46, v46, v4
    s_mov_b32 s88, 55050240
    v_cmp_lt_u32 vcc, v5, v49
    s_and_b64 exec, vcc, s[76:77]
    buffer_load_dwordx3 v[46:48], v46, s[12:15], s88 offen
    s_mov_b64 exec, -1
    s_cmp_eq_u64 s[52:53], 0
    s_cbranch_scc1 L_sx_32
    v_bfe_u32 v100, v54, 7, 12
    v_lshl_add_u32 v100, v100, 2, s82
    v_bfe_u32 v101, v55, 7, 12
    v_lshl_add_u32 v101, v101, 2, s82
    s_mov_b64 exec, s[52:53]
    ds_read_b32 v100, v100 offset:4096
    s_mov_b64 exec, s[74:75]
    ds_read_b32 v101, v101 offset:4096
    s_mov_b64 exec, -1
    s_waitcnt lgkmcnt(0)
    v_add_u32 v100, v100, v57
    v_add_u32 v101, v101, v122
    v_lshl_add_u32 v102, v100, 1, s89
    v_lshl_add_u32 v103, v101, 1, s89
    s_mov_b64 exec, s[52:53]
    ds_write_b32 v102, v54
    ds_write_b16 v100, v56
    s_mov_b64 exec, s[74:75]
    ds_write_b32 v103, v55
    ds_write_b16_d16_hi v101, v56
    s_mov_b64 exec, -1
L_sx_32:
    v_and_b32 v50, 0xffff, v89
    v_lshrrev_b32 v53, 16, v89
    v_lshlrev_b32 v50, 2, v50
    v_add_u32 v50, v50, v4
    s_mov_b32 s88, 61931520
    v_cmp_lt_u32 vcc, v5, v53
    s_and_b64 exec, vcc, s[76:77]
    buffer_load_dwordx3 v[50:52], v50, s[12:15], s88 offen
    s_mov_b64 exec, -1
    v_and_b32 v54, 0x1ffffff, v90
    v_lshrrev_b32 v57, 25, v90
    v_lshlrev_b32 v54, 2, v54
    v_mad_u32_u24 v54, v5, 6, v54
    s_mov_b32 s88, 0
    v_cmp_lt_u32 vcc, v5, v57
    s_and_b64 exec, vcc, s[76:77]
    buffer_load_dwordx3 v[54:56], v54, s[12:15], s88 offen
    s_mov_b64 exec, -1
    s_branch L_scate_31
L_noscat_30:
    s_lshl_b32 s78, 1, s80
    s_or_b32 s85, s85, s78
    s_mov_b32 s83, 0
    v_and_b32 v14, 0xffff, v80
    v_lshrrev_b32 v17, 16, v80
    v_lshlrev_b32 v14, 2, v14
    v_add_u32 v14, v14, v4
    s_mov_b32 s88, 0
    v_cmp_lt_u32 vcc, v5, v17
    s_and_b64 exec, vcc, s[76:77]
    buffer_load_dwordx3 v[14:16], v14, s[12:15], s88 offen
    s_mov_b64 exec, -1
    v_and_b32 v18, 0xffff, v81
    v_lshrrev_b32 v21, 16, v81
    v_lshlrev_b32 v18, 2, v18
    v_add_u32 v18, v18, v4
    s_mov_b32 s88, 6881280
    v_cmp_lt_u32 vcc, v5, v21
    s_and_b64 exec, vcc, s[76:77]
    buffer_load_dwordx3 v[18:20], v18, s[12:15], s88 offen
    s_mov_b64 exec, -1
    v_and_b32 v22, 0xffff, v82
    v_lshrrev_b32 v25, 16, v82
    v_lshlrev_b32 v22, 2, v22
    v_add_u32 v22, v22, v4
    s_mov_b32 s88, 13762560
    v_cmp_lt_u32 vcc, v5, v25
    s_and_b64 exec, vcc, s[76:77]
    buffer_load_dwordx3 v[22:24], v22, s[12:15], s88 offen
    s_mov_b64 exec, -1
    v_and_b32 v26, 0xffff, v83
    v_lshrrev_b32 v29, 16, v83
    v_lshlrev_b32 v26, 2, v26
    v_add_u32 v26, v26, v4
    s_mov_b32 s88, 20643840
    v_cmp_lt_u32 vcc, v5, v29
    s_and_b64 exec, vcc, s[76:77]
    buffer_load_dwordx3 v[26:28], v26, s[12:15], s88 offen
    s_mov_b64 exec, -1
    v_and_b32 v30, 0xffff, v84
    v_lshrrev_b32 v33, 16, v84
    v_lshlrev_b32 v30, 2, v30
    v_add_u32 v30, v30, v4
    s_mov_b32 s88, 27525120
    v_cmp_lt_u32 vcc, v5, v33
    s_and_b64 exec, vcc, s[76:77]
    buffer_load_dwordx3 v[30:32], v30, s[12:15], s88 offen
    s_mov_b64 exec, -1
    v_and_b32 v34, 0xffff, v85
    v_lshrrev_b32 v37, 16, v85
    v_lshlrev_b32 v34, 2, v34
    v_add_u32 v34, v34, v4
    s_mov_b32 s88, 34406400
    v_cmp_lt_u32 vcc, v5, v37
    s_and_b64 exec, vcc, s[76:77]
    buffer_load_dwordx3 v[34:36], v34, s[12:15], s88 offen
    s_mov_b64 exec, -1
    v_and_b32 v38, 0xffff, v86
    v_lshrrev_b32 v41, 16, v86
    v_lshlrev_b32 v38, 2, v38
    v_add_u32 v38, v38, v4
    s_mov_b32 s88, 41287680
    v_cmp_lt_u32 vcc, v5, v41
    s_and_b64 exec, vcc, s[76:77]
    buffer_load_dwordx3 v[38:40], v38, s[12:15], s88 offen
    s_mov_b64 exec, -1
    v_and_b32 v42, 0xffff, v87
    v_lshrrev_b32 v45, 16, v87
    v_lshlrev_b32 v42, 2, v42
    v_add_u32 v42, v42, v4
    s_mov_b32 s88, 48168960
    v_cmp_lt_u32 vcc, v5, v45
    s_and_b64 exec, vcc, s[76:77]
    buffer_load_dwordx3 v[42:44], v42, s[12:15], s88 offen
    s_mov_b64 exec, -1
    v_and_b32 v46, 0xffff, v88
    v_lshrrev_b32 v49, 16, v88
    v_lshlrev_b32 v46, 2, v46
    v_add_u32 v46, v46, v4
    s_mov_b32 s88, 55050240
    v_cmp_lt_u32 vcc, v5, v49
    s_and_b64 exec, vcc, s[76:77]
    buffer_load_dwordx3 v[46:48], v46, s[12:15], s88 offen
    s_mov_b64 exec, -1
    v_and_b32 v50, 0xffff, v89
    v_lshrrev_b32 v53, 16, v89
    v_lshlrev_b32 v50, 2, v50
    v_add_u32 v50, v50, v4
    s_mov_b32 s88, 61931520
    v_cmp_lt_u32 vcc, v5, v53
    s_and_b64 exec, vcc, s[76:77]
    buffer_load_dwordx3 v[50:52], v50, s[12:15], s88 offen
    s_mov_b64 exec, -1
    v_and_b32 v54, 0x1ffffff, v90
    v_lshrrev_b32 v57, 25, v90
    v_lshlrev_b32 v54, 2, v54
    v_mad_u32_u24 v54, v5, 6, v54
    s_mov_b32 s88, 0
    v_cmp_lt_u32 vcc, v5, v57
    s_and_b64 exec, vcc, s[76:77]
    buffer_load_dwordx3 v[54:56], v54, s[12:15], s88 offen
    s_mov_b64 exec, -1
L_scate_31:
    s_waitcnt lgkmcnt(0)
    s_barrier
    s_add_u32 s80, s80, 1
    s_cmp_eq_u32 s87, 0
    s_cbranch_scc1 L_RD_25
    s_cmp_gt_u32 s80, 1
    s_cbranch_scc1 L_P_26
L_RD_25:
    ds_read_b32 v58, v10 offset:0
    ds_read_b32 v59, v10 offset:256
    ds_read_u16 v92, v11 offset:0
    ds_read_u16 v93, v11 offset:128
    ds_read_b32 v60, v10 offset:8192
    ds_read_b32 v61, v10 offset:8448
    ds_read_u16 v94, v11 offset:4096
    ds_read_u16 v95, v11 offset:4224
    ds_read_b32 v62, v10 offset:16384
    ds_read_b32 v63, v10 offset:16640
    ds_read_u16 v96, v11 offset:8192
    ds_read_u16 v97, v11 offset:8320
    ds_read_b32 v64, v10 offset:24576
    ds_read_b32 v65, v10 offset:24832
    ds_read_u16 v98, v11 offset:12288
    ds_read_u16 v99, v11 offset:12416
    ds_read_b32 v66, v10 offset:32768
    ds_read_b32 v67, v10 offset:33024
    ds_read_u16 v100, v11 offset:16384
    ds_read_u16 v101, v11 offset:16512
    ds_read_b32 v68, v10 offset:40960
    ds_read_b32 v69, v10 offset:41216
    ds_read_u16 v102, v11 offset:20480
    ds_read_u16 v103, v11 offset:20608
    ds_read_b32 v70, v10 offset:49152
    ds_read_b32 v71, v10 offset:49408
    ds_read_u16 v104, v11 offset:24576
    ds_read_u16 v105, v11 offset:24704
    s_mov_b32 s84, s83
    s_waitcnt lgkmcnt(0)
    v_lshl_or_b32 v72, v93, 16, v92
    v_lshl_or_b32 v73, v95, 16, v94
    v_lshl_or_b32 v74, v97, 16, v96
    v_lshl_or_b32 v75, v99, 16, v98
    v_lshl_or_b32 v76, v101, 16, v100
    v_lshl_or_b32 v77, v103, 16, v102
    v_lshl_or_b32 v78, v105, 16, v104
    s_cmp_eq_u32 s87, 0
    s_cbranch_scc1 L_P_26
    s_cmp_lt_u32 s80, 3
    s_cbranch_scc1 L_HS_24
L_P_26:
    s_sub_i32 s78, s84, 0
    v_cmp_gt_i32 s[20:21], s78, v12
    v_and_b32 v13, 0x7ffff, v58
    s_mov_b64 exec, s[20:21]
    buffer_load_dwordx2 v[80:81], v13, s[16:19], 0 idxen
    s_mov_b64 exec, -1
    s_sub_i32 s78, s84, 64
    v_cmp_gt_i32 s[22:23], s78, v12
    v_and_b32 v1, 0x7ffff, v59
    s_mov_b64 exec, s[22:23]
    buffer_load_dwordx2 v[82:83], v1, s[16:19], 0 idxen
    s_mov_b64 exec, -1
    s_sub_i32 s78, s84, 2048
    v_cmp_gt_i32 s[24:25], s78, v12
    v_and_b32 v13, 0x7ffff, v60
    s_mov_b64 exec, s[24:25]
    buffer_load_dwordx2 v[84:85], v13, s[16:19], 0 idxen
    s_mov_b64 exec, -1
    s_sub_i32 s78, s84, 2112
    v_cmp_gt_i32 s[26:27], s78, v12
    v_and_b32 v1, 0x7ffff, v61
    s_mov_b64 exec, s[26:27]
    buffer_load_dwordx2 v[86:87], v1, s[16:19], 0 idxen
    s_mov_b64 exec, -1
    s_sub_i32 s78, s84, 4096
    v_cmp_gt_i32 s[28:29], s78, v12
    v_and_b32 v13, 0x7ffff, v62
    s_mov_b64 exec, s[28:29]
    buffer_load_dwordx2 v[88:89], v13, s[16:19], 0 idxen
    s_mov_b64 exec, -1
    s_sub_i32 s78, s84, 4160
    v_cmp_gt_i32 s[30:31], s78, v12
    v_and_b32 v1, 0x7ffff, v63
    s_mov_b64 exec, s[30:31]
    buffer_load_dwordx2 v[90:91], v1, s[16:19], 0 idxen
    s_mov_b64 exec, -1
    s_cmp_eq_u64 s[20:21], 0
    s_cbranch_scc1 L_psk_33
    v_lshrrev_b32 v92, 16, v58
    v_lshrrev_b32 v110, 16, v59
    v_and_b32 v92, 0x3ff8, v92
    v_and_b32 v110, 0x3ff8, v110
    v_add_u32 v93, v92, v92
    v_add_u32 v111, v110, v110
    ds_read_b128 v[94:97], v93 offset:29984
    ds_read_b64 v[98:99], v92 offset:49984
    ds_read_b128 v[112:115], v111 offset:29984
    ds_read_b64 v[116:117], v110 offset:49984
    v_lshlrev_b32 v100, 16, v72
    v_and_b32 v118, 0xffff0000, v72
    v_mul_f32 v100, 0.15915494, v100
    v_mul_f32 v118, 0.15915494, v118
    v_fract_f32 v100, v100
    v_fract_f32 v118, v118
    v_cos_f32 v100, v100
    v_cos_f32 v118, v118
    v_lshrrev_b32 v92, 1, v92
    v_lshrrev_b32 v110, 1, v110
    v_add_f32 v101, v100, v100
    v_add_f32 v119, v118, v118
    v_fma_f32 v102, v101, v100, -1.0
    v_fma_f32 v120, v119, v118, -1.0
    v_fma_f32 v103, v101, v102, -v100
    v_fma_f32 v121, v119, v120, -v118
    v_cvt_pk_bf16_f32 v104, v100, v102
    v_cvt_pk_bf16_f32 v122, v118, v120
    v_cvt_pk_bf16_f32 v105, v103, 0
    v_cvt_pk_bf16_f32 v93, 0, v103
    v_cvt_pk_bf16_f32 v123, v121, 0
    v_cvt_pk_bf16_f32 v111, 0, v121
    s_waitcnt vmcnt(4)
    v_lshlrev_b32 v100, 16, v80
    v_and_b32 v101, 0xffff0000, v80
    v_lshlrev_b32 v102, 16, v81
    v_and_b32 v103, 0xffff0000, v81
    v_lshlrev_b32 v118, 16, v82
    v_and_b32 v119, 0xffff0000, v82
    v_lshlrev_b32 v120, 16, v83
    v_and_b32 v121, 0xffff0000, v83
    s_waitcnt lgkmcnt(0)
    v_dot2_f32_bf16 v106, v98, v105, 0
    v_dot2_f32_bf16 v107, v98, v93, 0
    v_dot2_f32_bf16 v108, v99, v105, 0
    v_dot2_f32_bf16 v109, v99, v93, 0
    v_dot2_f32_bf16 v124, v116, v123, 0
    v_dot2_f32_bf16 v125, v116, v111, 0
    v_dot2_f32_bf16 v126, v117, v123, 0
    v_dot2_f32_bf16 v127, v117, v111, 0
    v_dot2_f32_bf16 v106, v94, v104, v106
    v_dot2_f32_bf16 v107, v95, v104, v107
    v_dot2_f32_bf16 v108, v96, v104, v108
    v_dot2_f32_bf16 v109, v97, v104, v109
    v_dot2_f32_bf16 v124, v112, v122, v124
    v_dot2_f32_bf16 v125, v113, v122, v125
    v_dot2_f32_bf16 v126, v114, v122, v126
    v_dot2_f32_bf16 v127, v115, v122, v127
    v_fma_f32 v106, v100, v106, v7
    v_fma_f32 v107, v101, v107, v7
    v_fma_f32 v108, v102, v108, v7
    v_fma_f32 v109, v103, v109, v7
    v_fma_f32 v124, v118, v124, v7
    v_fma_f32 v125, v119, v125, v7
    v_fma_f32 v126, v120, v126, v7
    v_fma_f32 v127, v121, v127, v7
    v_add_u32 v106, 0xb4c00000, v106
    v_add_u32 v107, 0xb4c00000, v107
    v_add_u32 v108, 0xb4c00000, v108
    v_add_u32 v109, 0xb4c00000, v109
    v_add_u32 v124, 0xb4c00000, v124
    v_add_u32 v125, 0xb4c00000, v125
    v_add_u32 v126, 0xb4c00000, v126
    v_add_u32 v127, 0xb4c00000, v127
    s_mov_b64 exec, s[20:21]
    ds_add_u32 v92, v106 offset:9984
    ds_add_u32 v92, v107 offset:14984
    ds_add_u32 v92, v108 offset:19984
    ds_add_u32 v92, v109 offset:24984
    s_mov_b64 exec, s[22:23]
    ds_add_u32 v110, v124 offset:9984
    ds_add_u32 v110, v125 offset:14984
    ds_add_u32 v110, v126 offset:19984
    ds_add_u32 v110, v127 offset:24984
    s_mov_b64 exec, -1
L_psk_33:
    s_sub_i32 s78, s84, 6144
    v_cmp_gt_i32 s[20:21], s78, v12
    v_and_b32 v13, 0x7ffff, v64
    s_mov_b64 exec, s[20:21]
    buffer_load_dwordx2 v[80:81], v13, s[16:19], 0 idxen
    s_mov_b64 exec, -1
    s_sub_i32 s78, s84, 6208
    v_cmp_gt_i32 s[22:23], s78, v12
    v_and_b32 v1, 0x7ffff, v65
    s_mov_b64 exec, s[22:23]
    buffer_load_dwordx2 v[82:83], v1, s[16:19], 0 idxen
    s_mov_b64 exec, -1
    s_cmp_eq_u64 s[24:25], 0
    s_cbranch_scc1 L_psk_34
    v_lshrrev_b32 v92, 16, v60
    v_lshrrev_b32 v110, 16, v61
    v_and_b32 v92, 0x3ff8, v92
    v_and_b32 v110, 0x3ff8, v110
    v_add_u32 v93, v92, v92
    v_add_u32 v111, v110, v110
    ds_read_b128 v[94:97], v93 offset:29984
    ds_read_b64 v[98:99], v92 offset:49984
    ds_read_b128 v[112:115], v111 offset:29984
    ds_read_b64 v[116:117], v110 offset:49984
    v_lshlrev_b32 v100, 16, v73
    v_and_b32 v118, 0xffff0000, v73
    v_mul_f32 v100, 0.15915494, v100
    v_mul_f32 v118, 0.15915494, v118
    v_fract_f32 v100, v100
    v_fract_f32 v118, v118
    v_cos_f32 v100, v100
    v_cos_f32 v118, v118
    v_lshrrev_b32 v92, 1, v92
    v_lshrrev_b32 v110, 1, v110
    v_add_f32 v101, v100, v100
    v_add_f32 v119, v118, v118
    v_fma_f32 v102, v101, v100, -1.0
    v_fma_f32 v120, v119, v118, -1.0
    v_fma_f32 v103, v101, v102, -v100
    v_fma_f32 v121, v119, v120, -v118
    v_cvt_pk_bf16_f32 v104, v100, v102
    v_cvt_pk_bf16_f32 v122, v118, v120
    v_cvt_pk_bf16_f32 v105, v103, 0
    v_cvt_pk_bf16_f32 v93, 0, v103
    v_cvt_pk_bf16_f32 v123, v121, 0
    v_cvt_pk_bf16_f32 v111, 0, v121
    s_waitcnt vmcnt(4)
    v_lshlrev_b32 v100, 16, v84
    v_and_b32 v101, 0xffff0000, v84
    v_lshlrev_b32 v102, 16, v85
    v_and_b32 v103, 0xffff0000, v85
    v_lshlrev_b32 v118, 16, v86
    v_and_b32 v119, 0xffff0000, v86
    v_lshlrev_b32 v120, 16, v87
    v_and_b32 v121, 0xffff0000, v87
    s_waitcnt lgkmcnt(0)
    v_dot2_f32_bf16 v106, v98, v105, 0
    v_dot2_f32_bf16 v107, v98, v93, 0
    v_dot2_f32_bf16 v108, v99, v105, 0
    v_dot2_f32_bf16 v109, v99, v93, 0
    v_dot2_f32_bf16 v124, v116, v123, 0
    v_dot2_f32_bf16 v125, v116, v111, 0
    v_dot2_f32_bf16 v126, v117, v123, 0
    v_dot2_f32_bf16 v127, v117, v111, 0
    v_dot2_f32_bf16 v106, v94, v104, v106
    v_dot2_f32_bf16 v107, v95, v104, v107
    v_dot2_f32_bf16 v108, v96, v104, v108
    v_dot2_f32_bf16 v109, v97, v104, v109
    v_dot2_f32_bf16 v124, v112, v122, v124
    v_dot2_f32_bf16 v125, v113, v122, v125
    v_dot2_f32_bf16 v126, v114, v122, v126
    v_dot2_f32_bf16 v127, v115, v122, v127
    v_fma_f32 v106, v100, v106, v7
    v_fma_f32 v107, v101, v107, v7
    v_fma_f32 v108, v102, v108, v7
    v_fma_f32 v109, v103, v109, v7
    v_fma_f32 v124, v118, v124, v7
    v_fma_f32 v125, v119, v125, v7
    v_fma_f32 v126, v120, v126, v7
    v_fma_f32 v127, v121, v127, v7
    v_add_u32 v106, 0xb4c00000, v106
    v_add_u32 v107, 0xb4c00000, v107
    v_add_u32 v108, 0xb4c00000, v108
    v_add_u32 v109, 0xb4c00000, v109
    v_add_u32 v124, 0xb4c00000, v124
    v_add_u32 v125, 0xb4c00000, v125
    v_add_u32 v126, 0xb4c00000, v126
    v_add_u32 v127, 0xb4c00000, v127
    s_mov_b64 exec, s[24:25]
    ds_add_u32 v92, v106 offset:9984
    ds_add_u32 v92, v107 offset:14984
    ds_add_u32 v92, v108 offset:19984
    ds_add_u32 v92, v109 offset:24984
    s_mov_b64 exec, s[26:27]
    ds_add_u32 v110, v124 offset:9984
    ds_add_u32 v110, v125 offset:14984
    ds_add_u32 v110, v126 offset:19984
    ds_add_u32 v110, v127 offset:24984
    s_mov_b64 exec, -1
L_psk_34:
    s_sub_i32 s78, s84, 8192
    v_cmp_gt_i32 s[24:25], s78, v12
    v_and_b32 v13, 0x7ffff, v66
    s_mov_b64 exec, s[24:25]
    buffer_load_dwordx2 v[84:85], v13, s[16:19], 0 idxen
    s_mov_b64 exec, -1
    s_sub_i32 s78, s84, 8256
    v_cmp_gt_i32 s[26:27], s78, v12
    v_and_b32 v1, 0x7ffff, v67
    s_mov_b64 exec, s[26:27]
    buffer_load_dwordx2 v[86:87], v1, s[16:19], 0 idxen
    s_mov_b64 exec, -1
    s_cmp_eq_u64 s[28:29], 0
    s_cbranch_scc1 L_psk_35
    v_lshrrev_b32 v92, 16, v62
    v_lshrrev_b32 v110, 16, v63
    v_and_b32 v92, 0x3ff8, v92
    v_and_b32 v110, 0x3ff8, v110
    v_add_u32 v93, v92, v92
    v_add_u32 v111, v110, v110
    ds_read_b128 v[94:97], v93 offset:29984
    ds_read_b64 v[98:99], v92 offset:49984
    ds_read_b128 v[112:115], v111 offset:29984
    ds_read_b64 v[116:117], v110 offset:49984
    v_lshlrev_b32 v100, 16, v74
    v_and_b32 v118, 0xffff0000, v74
    v_mul_f32 v100, 0.15915494, v100
    v_mul_f32 v118, 0.15915494, v118
    v_fract_f32 v100, v100
    v_fract_f32 v118, v118
    v_cos_f32 v100, v100
    v_cos_f32 v118, v118
    v_lshrrev_b32 v92, 1, v92
    v_lshrrev_b32 v110, 1, v110
    v_add_f32 v101, v100, v100
    v_add_f32 v119, v118, v118
    v_fma_f32 v102, v101, v100, -1.0
    v_fma_f32 v120, v119, v118, -1.0
    v_fma_f32 v103, v101, v102, -v100
    v_fma_f32 v121, v119, v120, -v118
    v_cvt_pk_bf16_f32 v104, v100, v102
    v_cvt_pk_bf16_f32 v122, v118, v120
    v_cvt_pk_bf16_f32 v105, v103, 0
    v_cvt_pk_bf16_f32 v93, 0, v103
    v_cvt_pk_bf16_f32 v123, v121, 0
    v_cvt_pk_bf16_f32 v111, 0, v121
    s_waitcnt vmcnt(4)
    v_lshlrev_b32 v100, 16, v88
    v_and_b32 v101, 0xffff0000, v88
    v_lshlrev_b32 v102, 16, v89
    v_and_b32 v103, 0xffff0000, v89
    v_lshlrev_b32 v118, 16, v90
    v_and_b32 v119, 0xffff0000, v90
    v_lshlrev_b32 v120, 16, v91
    v_and_b32 v121, 0xffff0000, v91
    s_waitcnt lgkmcnt(0)
    v_dot2_f32_bf16 v106, v98, v105, 0
    v_dot2_f32_bf16 v107, v98, v93, 0
    v_dot2_f32_bf16 v108, v99, v105, 0
    v_dot2_f32_bf16 v109, v99, v93, 0
    v_dot2_f32_bf16 v124, v116, v123, 0
    v_dot2_f32_bf16 v125, v116, v111, 0
    v_dot2_f32_bf16 v126, v117, v123, 0
    v_dot2_f32_bf16 v127, v117, v111, 0
    v_dot2_f32_bf16 v106, v94, v104, v106
    v_dot2_f32_bf16 v107, v95, v104, v107
    v_dot2_f32_bf16 v108, v96, v104, v108
    v_dot2_f32_bf16 v109, v97, v104, v109
    v_dot2_f32_bf16 v124, v112, v122, v124
    v_dot2_f32_bf16 v125, v113, v122, v125
    v_dot2_f32_bf16 v126, v114, v122, v126
    v_dot2_f32_bf16 v127, v115, v122, v127
    v_fma_f32 v106, v100, v106, v7
    v_fma_f32 v107, v101, v107, v7
    v_fma_f32 v108, v102, v108, v7
    v_fma_f32 v109, v103, v109, v7
    v_fma_f32 v124, v118, v124, v7
    v_fma_f32 v125, v119, v125, v7
    v_fma_f32 v126, v120, v126, v7
    v_fma_f32 v127, v121, v127, v7
    v_add_u32 v106, 0xb4c00000, v106
    v_add_u32 v107, 0xb4c00000, v107
    v_add_u32 v108, 0xb4c00000, v108
    v_add_u32 v109, 0xb4c00000, v109
    v_add_u32 v124, 0xb4c00000, v124
    v_add_u32 v125, 0xb4c00000, v125
    v_add_u32 v126, 0xb4c00000, v126
    v_add_u32 v127, 0xb4c00000, v127
    s_mov_b64 exec, s[28:29]
    ds_add_u32 v92, v106 offset:9984
    ds_add_u32 v92, v107 offset:14984
    ds_add_u32 v92, v108 offset:19984
    ds_add_u32 v92, v109 offset:24984
    s_mov_b64 exec, s[30:31]
    ds_add_u32 v110, v124 offset:9984
    ds_add_u32 v110, v125 offset:14984
    ds_add_u32 v110, v126 offset:19984
    ds_add_u32 v110, v127 offset:24984
    s_mov_b64 exec, -1
L_psk_35:
    s_sub_i32 s78, s84, 10240
    v_cmp_gt_i32 s[28:29], s78, v12
    v_and_b32 v13, 0x7ffff, v68
    s_mov_b64 exec, s[28:29]
    buffer_load_dwordx2 v[88:89], v13, s[16:19], 0 idxen
    s_mov_b64 exec, -1
    s_sub_i32 s78, s84, 10304
    v_cmp_gt_i32 s[30:31], s78, v12
    v_and_b32 v1, 0x7ffff, v69
    s_mov_b64 exec, s[30:31]
    buffer_load_dwordx2 v[90:91], v1, s[16:19], 0 idxen
    s_mov_b64 exec, -1
    s_cmp_eq_u64 s[20:21], 0
    s_cbranch_scc1 L_psk_36
    v_lshrrev_b32 v92, 16, v64
    v_lshrrev_b32 v110, 16, v65
    v_and_b32 v92, 0x3ff8, v92
    v_and_b32 v110, 0x3ff8, v110
    v_add_u32 v93, v92, v92
    v_add_u32 v111, v110, v110
    ds_read_b128 v[94:97], v93 offset:29984
    ds_read_b64 v[98:99], v92 offset:49984
    ds_read_b128 v[112:115], v111 offset:29984
    ds_read_b64 v[116:117], v110 offset:49984
    v_lshlrev_b32 v100, 16, v75
    v_and_b32 v118, 0xffff0000, v75
    v_mul_f32 v100, 0.15915494, v100
    v_mul_f32 v118, 0.15915494, v118
    v_fract_f32 v100, v100
    v_fract_f32 v118, v118
    v_cos_f32 v100, v100
    v_cos_f32 v118, v118
    v_lshrrev_b32 v92, 1, v92
    v_lshrrev_b32 v110, 1, v110
    v_add_f32 v101, v100, v100
    v_add_f32 v119, v118, v118
    v_fma_f32 v102, v101, v100, -1.0
    v_fma_f32 v120, v119, v118, -1.0
    v_fma_f32 v103, v101, v102, -v100
    v_fma_f32 v121, v119, v120, -v118
    v_cvt_pk_bf16_f32 v104, v100, v102
    v_cvt_pk_bf16_f32 v122, v118, v120
    v_cvt_pk_bf16_f32 v105, v103, 0
    v_cvt_pk_bf16_f32 v93, 0, v103
    v_cvt_pk_bf16_f32 v123, v121, 0
    v_cvt_pk_bf16_f32 v111, 0, v121
    s_waitcnt vmcnt(4)
    v_lshlrev_b32 v100, 16, v80
    v_and_b32 v101, 0xffff0000, v80
    v_lshlrev_b32 v102, 16, v81
    v_and_b32 v103, 0xffff0000, v81
    v_lshlrev_b32 v118, 16, v82
    v_and_b32 v119, 0xffff0000, v82
    v_lshlrev_b32 v120, 16, v83
    v_and_b32 v121, 0xffff0000, v83
    s_waitcnt lgkmcnt(0)
    v_dot2_f32_bf16 v106, v98, v105, 0
    v_dot2_f32_bf16 v107, v98, v93, 0
    v_dot2_f32_bf16 v108, v99, v105, 0
    v_dot2_f32_bf16 v109, v99, v93, 0
    v_dot2_f32_bf16 v124, v116, v123, 0
    v_dot2_f32_bf16 v125, v116, v111, 0
    v_dot2_f32_bf16 v126, v117, v123, 0
    v_dot2_f32_bf16 v127, v117, v111, 0
    v_dot2_f32_bf16 v106, v94, v104, v106
    v_dot2_f32_bf16 v107, v95, v104, v107
    v_dot2_f32_bf16 v108, v96, v104, v108
    v_dot2_f32_bf16 v109, v97, v104, v109
    v_dot2_f32_bf16 v124, v112, v122, v124
    v_dot2_f32_bf16 v125, v113, v122, v125
    v_dot2_f32_bf16 v126, v114, v122, v126
    v_dot2_f32_bf16 v127, v115, v122, v127
    v_fma_f32 v106, v100, v106, v7
    v_fma_f32 v107, v101, v107, v7
    v_fma_f32 v108, v102, v108, v7
    v_fma_f32 v109, v103, v109, v7
    v_fma_f32 v124, v118, v124, v7
    v_fma_f32 v125, v119, v125, v7
    v_fma_f32 v126, v120, v126, v7
    v_fma_f32 v127, v121, v127, v7
    v_add_u32 v106, 0xb4c00000, v106
    v_add_u32 v107, 0xb4c00000, v107
    v_add_u32 v108, 0xb4c00000, v108
    v_add_u32 v109, 0xb4c00000, v109
    v_add_u32 v124, 0xb4c00000, v124
    v_add_u32 v125, 0xb4c00000, v125
    v_add_u32 v126, 0xb4c00000, v126
    v_add_u32 v127, 0xb4c00000, v127
    s_mov_b64 exec, s[20:21]
    ds_add_u32 v92, v106 offset:9984
    ds_add_u32 v92, v107 offset:14984
    ds_add_u32 v92, v108 offset:19984
    ds_add_u32 v92, v109 offset:24984
    s_mov_b64 exec, s[22:23]
    ds_add_u32 v110, v124 offset:9984
    ds_add_u32 v110, v125 offset:14984
    ds_add_u32 v110, v126 offset:19984
    ds_add_u32 v110, v127 offset:24984
    s_mov_b64 exec, -1
L_psk_36:
    s_sub_i32 s78, s84, 12288
    v_cmp_gt_i32 s[20:21], s78, v12
    v_and_b32 v13, 0x7ffff, v70
    s_mov_b64 exec, s[20:21]
    buffer_load_dwordx2 v[80:81], v13, s[16:19], 0 idxen
    s_mov_b64 exec, -1
    s_sub_i32 s78, s84, 12352
    v_cmp_gt_i32 s[22:23], s78, v12
    v_and_b32 v1, 0x7ffff, v71
    s_mov_b64 exec, s[22:23]
    buffer_load_dwordx2 v[82:83], v1, s[16:19], 0 idxen
    s_mov_b64 exec, -1
    s_cmp_eq_u64 s[24:25], 0
    s_cbranch_scc1 L_psk_37
    v_lshrrev_b32 v92, 16, v66
    v_lshrrev_b32 v110, 16, v67
    v_and_b32 v92, 0x3ff8, v92
    v_and_b32 v110, 0x3ff8, v110
    v_add_u32 v93, v92, v92
    v_add_u32 v111, v110, v110
    ds_read_b128 v[94:97], v93 offset:29984
    ds_read_b64 v[98:99], v92 offset:49984
    ds_read_b128 v[112:115], v111 offset:29984
    ds_read_b64 v[116:117], v110 offset:49984
    v_lshlrev_b32 v100, 16, v76
    v_and_b32 v118, 0xffff0000, v76
    v_mul_f32 v100, 0.15915494, v100
    v_mul_f32 v118, 0.15915494, v118
    v_fract_f32 v100, v100
    v_fract_f32 v118, v118
    v_cos_f32 v100, v100
    v_cos_f32 v118, v118
    v_lshrrev_b32 v92, 1, v92
    v_lshrrev_b32 v110, 1, v110
    v_add_f32 v101, v100, v100
    v_add_f32 v119, v118, v118
    v_fma_f32 v102, v101, v100, -1.0
    v_fma_f32 v120, v119, v118, -1.0
    v_fma_f32 v103, v101, v102, -v100
    v_fma_f32 v121, v119, v120, -v118
    v_cvt_pk_bf16_f32 v104, v100, v102
    v_cvt_pk_bf16_f32 v122, v118, v120
    v_cvt_pk_bf16_f32 v105, v103, 0
    v_cvt_pk_bf16_f32 v93, 0, v103
    v_cvt_pk_bf16_f32 v123, v121, 0
    v_cvt_pk_bf16_f32 v111, 0, v121
    s_waitcnt vmcnt(4)
    v_lshlrev_b32 v100, 16, v84
    v_and_b32 v101, 0xffff0000, v84
    v_lshlrev_b32 v102, 16, v85
    v_and_b32 v103, 0xffff0000, v85
    v_lshlrev_b32 v118, 16, v86
    v_and_b32 v119, 0xffff0000, v86
    v_lshlrev_b32 v120, 16, v87
    v_and_b32 v121, 0xffff0000, v87
    s_waitcnt lgkmcnt(0)
    v_dot2_f32_bf16 v106, v98, v105, 0
    v_dot2_f32_bf16 v107, v98, v93, 0
    v_dot2_f32_bf16 v108, v99, v105, 0
    v_dot2_f32_bf16 v109, v99, v93, 0
    v_dot2_f32_bf16 v124, v116, v123, 0
    v_dot2_f32_bf16 v125, v116, v111, 0
    v_dot2_f32_bf16 v126, v117, v123, 0
    v_dot2_f32_bf16 v127, v117, v111, 0
    v_dot2_f32_bf16 v106, v94, v104, v106
    v_dot2_f32_bf16 v107, v95, v104, v107
    v_dot2_f32_bf16 v108, v96, v104, v108
    v_dot2_f32_bf16 v109, v97, v104, v109
    v_dot2_f32_bf16 v124, v112, v122, v124
    v_dot2_f32_bf16 v125, v113, v122, v125
    v_dot2_f32_bf16 v126, v114, v122, v126
    v_dot2_f32_bf16 v127, v115, v122, v127
    v_fma_f32 v106, v100, v106, v7
    v_fma_f32 v107, v101, v107, v7
    v_fma_f32 v108, v102, v108, v7
    v_fma_f32 v109, v103, v109, v7
    v_fma_f32 v124, v118, v124, v7
    v_fma_f32 v125, v119, v125, v7
    v_fma_f32 v126, v120, v126, v7
    v_fma_f32 v127, v121, v127, v7
    v_add_u32 v106, 0xb4c00000, v106
    v_add_u32 v107, 0xb4c00000, v107
    v_add_u32 v108, 0xb4c00000, v108
    v_add_u32 v109, 0xb4c00000, v109
    v_add_u32 v124, 0xb4c00000, v124
    v_add_u32 v125, 0xb4c00000, v125
    v_add_u32 v126, 0xb4c00000, v126
    v_add_u32 v127, 0xb4c00000, v127
    s_mov_b64 exec, s[24:25]
    ds_add_u32 v92, v106 offset:9984
    ds_add_u32 v92, v107 offset:14984
    ds_add_u32 v92, v108 offset:19984
    ds_add_u32 v92, v109 offset:24984
    s_mov_b64 exec, s[26:27]
    ds_add_u32 v110, v124 offset:9984
    ds_add_u32 v110, v125 offset:14984
    ds_add_u32 v110, v126 offset:19984
    ds_add_u32 v110, v127 offset:24984
    s_mov_b64 exec, -1
L_psk_37:
    s_cmp_eq_u64 s[28:29], 0
    s_cbranch_scc1 L_psk_38
    v_lshrrev_b32 v92, 16, v68
    v_lshrrev_b32 v110, 16, v69
    v_and_b32 v92, 0x3ff8, v92
    v_and_b32 v110, 0x3ff8, v110
    v_add_u32 v93, v92, v92
    v_add_u32 v111, v110, v110
    ds_read_b128 v[94:97], v93 offset:29984
    ds_read_b64 v[98:99], v92 offset:49984
    ds_read_b128 v[112:115], v111 offset:29984
    ds_read_b64 v[116:117], v110 offset:49984
    v_lshlrev_b32 v100, 16, v77
    v_and_b32 v118, 0xffff0000, v77
    v_mul_f32 v100, 0.15915494, v100
    v_mul_f32 v118, 0.15915494, v118
    v_fract_f32 v100, v100
    v_fract_f32 v118, v118
    v_cos_f32 v100, v100
    v_cos_f32 v118, v118
    v_lshrrev_b32 v92, 1, v92
    v_lshrrev_b32 v110, 1, v110
    v_add_f32 v101, v100, v100
    v_add_f32 v119, v118, v118
    v_fma_f32 v102, v101, v100, -1.0
    v_fma_f32 v120, v119, v118, -1.0
    v_fma_f32 v103, v101, v102, -v100
    v_fma_f32 v121, v119, v120, -v118
    v_cvt_pk_bf16_f32 v104, v100, v102
    v_cvt_pk_bf16_f32 v122, v118, v120
    v_cvt_pk_bf16_f32 v105, v103, 0
    v_cvt_pk_bf16_f32 v93, 0, v103
    v_cvt_pk_bf16_f32 v123, v121, 0
    v_cvt_pk_bf16_f32 v111, 0, v121
    s_waitcnt vmcnt(2)
    v_lshlrev_b32 v100, 16, v88
    v_and_b32 v101, 0xffff0000, v88
    v_lshlrev_b32 v102, 16, v89
    v_and_b32 v103, 0xffff0000, v89
    v_lshlrev_b32 v118, 16, v90
    v_and_b32 v119, 0xffff0000, v90
    v_lshlrev_b32 v120, 16, v91
    v_and_b32 v121, 0xffff0000, v91
    s_waitcnt lgkmcnt(0)
    v_dot2_f32_bf16 v106, v98, v105, 0
    v_dot2_f32_bf16 v107, v98, v93, 0
    v_dot2_f32_bf16 v108, v99, v105, 0
    v_dot2_f32_bf16 v109, v99, v93, 0
    v_dot2_f32_bf16 v124, v116, v123, 0
    v_dot2_f32_bf16 v125, v116, v111, 0
    v_dot2_f32_bf16 v126, v117, v123, 0
    v_dot2_f32_bf16 v127, v117, v111, 0
    v_dot2_f32_bf16 v106, v94, v104, v106
    v_dot2_f32_bf16 v107, v95, v104, v107
    v_dot2_f32_bf16 v108, v96, v104, v108
    v_dot2_f32_bf16 v109, v97, v104, v109
    v_dot2_f32_bf16 v124, v112, v122, v124
    v_dot2_f32_bf16 v125, v113, v122, v125
    v_dot2_f32_bf16 v126, v114, v122, v126
    v_dot2_f32_bf16 v127, v115, v122, v127
    v_fma_f32 v106, v100, v106, v7
    v_fma_f32 v107, v101, v107, v7
    v_fma_f32 v108, v102, v108, v7
    v_fma_f32 v109, v103, v109, v7
    v_fma_f32 v124, v118, v124, v7
    v_fma_f32 v125, v119, v125, v7
    v_fma_f32 v126, v120, v126, v7
    v_fma_f32 v127, v121, v127, v7
    v_add_u32 v106, 0xb4c00000, v106
    v_add_u32 v107, 0xb4c00000, v107
    v_add_u32 v108, 0xb4c00000, v108
    v_add_u32 v109, 0xb4c00000, v109
    v_add_u32 v124, 0xb4c00000, v124
    v_add_u32 v125, 0xb4c00000, v125
    v_add_u32 v126, 0xb4c00000, v126
    v_add_u32 v127, 0xb4c00000, v127
    s_mov_b64 exec, s[28:29]
    ds_add_u32 v92, v106 offset:9984
    ds_add_u32 v92, v107 offset:14984
    ds_add_u32 v92, v108 offset:19984
    ds_add_u32 v92, v109 offset:24984
    s_mov_b64 exec, s[30:31]
    ds_add_u32 v110, v124 offset:9984
    ds_add_u32 v110, v125 offset:14984
    ds_add_u32 v110, v126 offset:19984
    ds_add_u32 v110, v127 offset:24984
    s_mov_b64 exec, -1
L_psk_38:
    s_cmp_eq_u64 s[20:21], 0
    s_cbranch_scc1 L_psk_39
    v_lshrrev_b32 v92, 16, v70
    v_lshrrev_b32 v110, 16, v71
    v_and_b32 v92, 0x3ff8, v92
    v_and_b32 v110, 0x3ff8, v110
    v_add_u32 v93, v92, v92
    v_add_u32 v111, v110, v110
    ds_read_b128 v[94:97], v93 offset:29984
    ds_read_b64 v[98:99], v92 offset:49984
    ds_read_b128 v[112:115], v111 offset:29984
    ds_read_b64 v[116:117], v110 offset:49984
    v_lshlrev_b32 v100, 16, v78
    v_and_b32 v118, 0xffff0000, v78
    v_mul_f32 v100, 0.15915494, v100
    v_mul_f32 v118, 0.15915494, v118
    v_fract_f32 v100, v100
    v_fract_f32 v118, v118
    v_cos_f32 v100, v100
    v_cos_f32 v118, v118
    v_lshrrev_b32 v92, 1, v92
    v_lshrrev_b32 v110, 1, v110
    v_add_f32 v101, v100, v100
    v_add_f32 v119, v118, v118
    v_fma_f32 v102, v101, v100, -1.0
    v_fma_f32 v120, v119, v118, -1.0
    v_fma_f32 v103, v101, v102, -v100
    v_fma_f32 v121, v119, v120, -v118
    v_cvt_pk_bf16_f32 v104, v100, v102
    v_cvt_pk_bf16_f32 v122, v118, v120
    v_cvt_pk_bf16_f32 v105, v103, 0
    v_cvt_pk_bf16_f32 v93, 0, v103
    v_cvt_pk_bf16_f32 v123, v121, 0
    v_cvt_pk_bf16_f32 v111, 0, v121
    s_waitcnt vmcnt(0)
    v_lshlrev_b32 v100, 16, v80
    v_and_b32 v101, 0xffff0000, v80
    v_lshlrev_b32 v102, 16, v81
    v_and_b32 v103, 0xffff0000, v81
    v_lshlrev_b32 v118, 16, v82
    v_and_b32 v119, 0xffff0000, v82
    v_lshlrev_b32 v120, 16, v83
    v_and_b32 v121, 0xffff0000, v83
    s_waitcnt lgkmcnt(0)
    v_dot2_f32_bf16 v106, v98, v105, 0
    v_dot2_f32_bf16 v107, v98, v93, 0
    v_dot2_f32_bf16 v108, v99, v105, 0
    v_dot2_f32_bf16 v109, v99, v93, 0
    v_dot2_f32_bf16 v124, v116, v123, 0
    v_dot2_f32_bf16 v125, v116, v111, 0
    v_dot2_f32_bf16 v126, v117, v123, 0
    v_dot2_f32_bf16 v127, v117, v111, 0
    v_dot2_f32_bf16 v106, v94, v104, v106
    v_dot2_f32_bf16 v107, v95, v104, v107
    v_dot2_f32_bf16 v108, v96, v104, v108
    v_dot2_f32_bf16 v109, v97, v104, v109
    v_dot2_f32_bf16 v124, v112, v122, v124
    v_dot2_f32_bf16 v125, v113, v122, v125
    v_dot2_f32_bf16 v126, v114, v122, v126
    v_dot2_f32_bf16 v127, v115, v122, v127
    v_fma_f32 v106, v100, v106, v7
    v_fma_f32 v107, v101, v107, v7
    v_fma_f32 v108, v102, v108, v7
    v_fma_f32 v109, v103, v109, v7
    v_fma_f32 v124, v118, v124, v7
    v_fma_f32 v125, v119, v125, v7
    v_fma_f32 v126, v120, v126, v7
    v_fma_f32 v127, v121, v127, v7
    v_add_u32 v106, 0xb4c00000, v106
    v_add_u32 v107, 0xb4c00000, v107
    v_add_u32 v108, 0xb4c00000, v108
    v_add_u32 v109, 0xb4c00000, v109
    v_add_u32 v124, 0xb4c00000, v124
    v_add_u32 v125, 0xb4c00000, v125
    v_add_u32 v126, 0xb4c00000, v126
    v_add_u32 v127, 0xb4c00000, v127
    s_mov_b64 exec, s[20:21]
    ds_add_u32 v92, v106 offset:9984
    ds_add_u32 v92, v107 offset:14984
    ds_add_u32 v92, v108 offset:19984
    ds_add_u32 v92, v109 offset:24984
    s_mov_b64 exec, s[22:23]
    ds_add_u32 v110, v124 offset:9984
    ds_add_u32 v110, v125 offset:14984
    ds_add_u32 v110, v126 offset:19984
    ds_add_u32 v110, v127 offset:24984
    s_mov_b64 exec, -1
L_psk_39:
    s_add_u32 s81, s81, 1
    s_cmp_eq_u32 s81, 3
    s_cbranch_scc1 L_END_27
    s_cmp_eq_u32 s87, 0
    s_cbranch_scc1 L_HS_24
    s_branch L_RD_25
L_END_27:
    s_cmp_eq_u32 s85, 0
    s_cbranch_scc1 L_dire_40
    s_mov_b32 s88, 0
L_dg_41:
    s_lshr_b32 s78, s85, s88
    s_and_b32 s78, s78, 17
    s_cmp_eq_u32 s78, 0
    s_cbranch_scc1 L_dgn_42
    s_bitcmp1_b32 s78, 0
    s_cselect_b32 s90, 0, 1
    s_mov_b32 s89, 0
L_slot_43:
    s_mul_i32 s78, s89, 1536
    s_lshl_b32 s79, s88, 2
    s_add_u32 s78, s78, s79
    v_add_u32 v13, s78, v8
    ds_read_b32 v58, v13
    s_mul_i32 s76, s89, 6881280
    s_mov_b32 s77, s90
    s_waitcnt lgkmcnt(0)
    v_and_b32 v59, 0xffff, v58
    v_lshrrev_b32 v58, 16, v58
    v_lshlrev_b32 v59, 2, v59
    v_add_u32 v59, v59, v4
L_dirc_44:
    s_lshl_b32 s78, s77, 4
    v_subrev_u32 v60, s78, v58
    v_cmp_lt_i32 s[20:21], v5, v60
    v_cmp_lt_i32 s[22:23], v6, v60
    s_cmp_eq_u64 s[20:21], 0
    s_cbranch_scc1 L_dirn_45
    s_mul_i32 s78, s77, 96
    v_add_u32 v61, s78, v59
    s_mov_b64 exec, s[20:21]
    buffer_load_dwordx3 v[88:90], v61, s[12:15], s76 offen
    s_mov_b64 exec, -1
    s_waitcnt vmcnt(0)
    v_and_b32 v13, 0x7ffff, v88
    s_mov_b64 exec, s[20:21]
    buffer_load_dwordx2 v[80:81], v13, s[16:19], 0 idxen
    s_mov_b64 exec, -1
    v_and_b32 v13, 0x7ffff, v89
    s_mov_b64 exec, s[22:23]
    buffer_load_dwordx2 v[82:83], v13, s[16:19], 0 idxen
    s_mov_b64 exec, -1
    v_lshrrev_b32 v92, 16, v88
    v_lshrrev_b32 v110, 16, v89
    v_and_b32 v92, 0x3ff8, v92
    v_and_b32 v110, 0x3ff8, v110
    v_add_u32 v93, v92, v92
    v_add_u32 v111, v110, v110
    ds_read_b128 v[94:97], v93 offset:29984
    ds_read_b64 v[98:99], v92 offset:49984
    ds_read_b128 v[112:115], v111 offset:29984
    ds_read_b64 v[116:117], v110 offset:49984
    v_lshlrev_b32 v100, 16, v90
    v_and_b32 v118, 0xffff0000, v90
    v_mul_f32 v100, 0.15915494, v100
    v_mul_f32 v118, 0.15915494, v118
    v_fract_f32 v100, v100
    v_fract_f32 v118, v118
    v_cos_f32 v100, v100
    v_cos_f32 v118, v118
    v_lshrrev_b32 v92, 1, v92
    v_lshrrev_b32 v110, 1, v110
    v_add_f32 v101, v100, v100
    v_add_f32 v119, v118, v118
    v_fma_f32 v102, v101, v100, -1.0
    v_fma_f32 v120, v119, v118, -1.0
    v_fma_f32 v103, v101, v102, -v100
    v_fma_f32 v121, v119, v120, -v118
    v_cvt_pk_bf16_f32 v104, v100, v102
    v_cvt_pk_bf16_f32 v122, v118, v120
    v_cvt_pk_bf16_f32 v105, v103, 0
    v_cvt_pk_bf16_f32 v93, 0, v103
    v_cvt_pk_bf16_f32 v123, v121, 0
    v_cvt_pk_bf16_f32 v111, 0, v121
    s_waitcnt vmcnt(0)
    v_lshlrev_b32 v100, 16, v80
    v_and_b32 v101, 0xffff0000, v80
    v_lshlrev_b32 v102, 16, v81
    v_and_b32 v103, 0xffff0000, v81
    v_lshlrev_b32 v118, 16, v82
    v_and_b32 v119, 0xffff0000, v82
    v_lshlrev_b32 v120, 16, v83
    v_and_b32 v121, 0xffff0000, v83
    s_waitcnt lgkmcnt(0)
    v_dot2_f32_bf16 v106, v98, v105, 0
    v_dot2_f32_bf16 v107, v98, v93, 0
    v_dot2_f32_bf16 v108, v99, v105, 0
    v_dot2_f32_bf16 v109, v99, v93, 0
    v_dot2_f32_bf16 v124, v116, v123, 0
    v_dot2_f32_bf16 v125, v116, v111, 0
    v_dot2_f32_bf16 v126, v117, v123, 0
    v_dot2_f32_bf16 v127, v117, v111, 0
    v_dot2_f32_bf16 v106, v94, v104, v106
    v_dot2_f32_bf16 v107, v95, v104, v107
    v_dot2_f32_bf16 v108, v96, v104, v108
    v_dot2_f32_bf16 v109, v97, v104, v109
    v_dot2_f32_bf16 v124, v112, v122, v124
    v_dot2_f32_bf16 v125, v113, v122, v125
    v_dot2_f32_bf16 v126, v114, v122, v126
    v_dot2_f32_bf16 v127, v115, v122, v127
    v_fma_f32 v106, v100, v106, v7
    v_fma_f32 v107, v101, v107, v7
    v_fma_f32 v108, v102, v108, v7
    v_fma_f32 v109, v103, v109, v7
    v_fma_f32 v124, v118, v124, v7
    v_fma_f32 v125, v119, v125, v7
    v_fma_f32 v126, v120, v126, v7
    v_fma_f32 v127, v121, v127, v7
    v_add_u32 v106, 0xb4c00000, v106
    v_add_u32 v107, 0xb4c00000, v107
    v_add_u32 v108, 0xb4c00000, v108
    v_add_u32 v109, 0xb4c00000, v109
    v_add_u32 v124, 0xb4c00000, v124
    v_add_u32 v125, 0xb4c00000, v125
    v_add_u32 v126, 0xb4c00000, v126
    v_add_u32 v127, 0xb4c00000, v127
    s_mov_b64 exec, s[20:21]
    ds_add_u32 v92, v106 offset:9984
    ds_add_u32 v92, v107 offset:14984
    ds_add_u32 v92, v108 offset:19984
    ds_add_u32 v92, v109 offset:24984
    s_mov_b64 exec, s[22:23]
    ds_add_u32 v110, v124 offset:9984
    ds_add_u32 v110, v125 offset:14984
    ds_add_u32 v110, v126 offset:19984
    ds_add_u32 v110, v127 offset:24984
    s_mov_b64 exec, -1
    s_add_u32 s77, s77, 1
    s_branch L_dirc_44
L_dirn_45:
    s_add_u32 s89, s89, 1
    s_cmp_lt_u32 s89, 10
    s_cbranch_scc1 L_slot_43
L_dgn_42:
    s_add_u32 s88, s88, 1
    s_cmp_lt_u32 s88, 3
    s_cbranch_scc1 L_dg_41
L_dire_40:
    s_load_dwordx4 s[68:71], s[0:1], 80
    v_add_u32 v16, s7, v0
    v_add_u32 v17, 1024, v16
    v_lshlrev_b32 v13, 5, v16
    s_mov_b32 s6, 73154560
    s_waitcnt vmcnt(0)
    buffer_load_dwordx2 v[20:21], v16, s[8:11], 0 idxen
    buffer_load_dwordx4 v[24:27], v13, s[12:15], s6 offen
    buffer_load_dwordx4 v[28:31], v13, s[12:15], s6 offen offset:16
    v_cmp_gt_u32 vcc, 226, v0
    s_mov_b64 s[72:73], vcc
    s_mov_b64 exec, s[72:73]
    s_add_u32 s6, s6, 32768
    buffer_load_dwordx2 v[22:23], v17, s[8:11], 0 idxen
    buffer_load_dwordx4 v[32:35], v13, s[12:15], s6 offen
    buffer_load_dwordx4 v[36:39], v13, s[12:15], s6 offen offset:16
    s_mov_b64 exec, -1
    s_waitcnt lgkmcnt(0)
    s_load_dwordx8 s[20:27], s[68:69], 0
    s_mov_b32 s16, s70
    s_and_b32 s17, s71, 0xffff
    s_or_b32 s17, s17, 0x80000
    s_mov_b32 s18, 320000
    s_mov_b32 s19, 0x00020000
    s_waitcnt lgkmcnt(0)
    s_lshl_b32 s28, s20, 16
    s_and_b32 s29, s20, 0xffff0000
    s_lshl_b32 s30, s21, 16
    s_and_b32 s31, s21, 0xffff0000
    s_lshl_b32 s32, s22, 16
    s_and_b32 s33, s22, 0xffff0000
    s_lshl_b32 s34, s23, 16
    s_and_b32 s35, s23, 0xffff0000
    s_lshl_b32 s36, s24, 16
    s_and_b32 s37, s24, 0xffff0000
    s_lshl_b32 s38, s25, 16
    s_and_b32 s39, s25, 0xffff0000
    s_lshl_b32 s40, s26, 16
    s_and_b32 s41, s26, 0xffff0000
    s_lshl_b32 s42, s27, 16
    s_and_b32 s43, s27, 0xffff0000
    s_barrier
    v_lshlrev_b32 v48, 2, v0
    ds_read_b32 v40, v48 offset:9984
    ds_read_b32 v41, v48 offset:14984
    ds_read_b32 v42, v48 offset:19984
    ds_read_b32 v43, v48 offset:24984
    s_waitcnt vmcnt(0) lgkmcnt(0)
    v_cvt_f32_i32 v40, v40
    v_cvt_f32_i32 v41, v41
    v_cvt_f32_i32 v42, v42
    v_cvt_f32_i32 v43, v43
    v_mul_f32 v40, v40, v24
    v_mul_f32 v41, v41, v25
    v_mul_f32 v42, v42, v26
    v_mul_f32 v43, v43, v27
    v_mul_f32 v44, s28, v40
    v_mul_f32 v45, s29, v40
    v_mul_f32 v46, s30, v40
    v_mul_f32 v47, s31, v40
    v_fmac_f32 v44, s32, v41
    v_fmac_f32 v45, s33, v41
    v_fmac_f32 v46, s34, v41
    v_fmac_f32 v47, s35, v41
    v_fmac_f32 v44, s36, v42
    v_fmac_f32 v45, s37, v42
    v_fmac_f32 v46, s38, v42
    v_fmac_f32 v47, s39, v42
    v_fmac_f32 v44, s40, v43
    v_fmac_f32 v45, s41, v43
    v_fmac_f32 v46, s42, v43
    v_fmac_f32 v47, s43, v43
    v_lshlrev_b32 v40, 16, v20
    v_and_b32 v41, 0xffff0000, v20
    v_lshlrev_b32 v42, 16, v21
    v_and_b32 v43, 0xffff0000, v21
    v_fmac_f32 v40, v44, v28
    v_fmac_f32 v41, v45, v29
    v_fmac_f32 v42, v46, v30
    v_fmac_f32 v43, v47, v31
    v_cvt_pk_bf16_f32 v44, v40, v41
    v_cvt_pk_bf16_f32 v45, v42, v43
    buffer_store_dwordx2 v[44:45], v16, s[16:19], 0 idxen
    s_mov_b64 exec, s[72:73]
    s_cbranch_execz L_epi1_46
    v_lshlrev_b32 v48, 2, v0
    ds_read_b32 v40, v48 offset:14080
    ds_read_b32 v41, v48 offset:19080
    ds_read_b32 v42, v48 offset:24080
    ds_read_b32 v43, v48 offset:29080
    s_waitcnt vmcnt(0) lgkmcnt(0)
    v_cvt_f32_i32 v40, v40
    v_cvt_f32_i32 v41, v41
    v_cvt_f32_i32 v42, v42
    v_cvt_f32_i32 v43, v43
    v_mul_f32 v40, v40, v32
    v_mul_f32 v41, v41, v33
    v_mul_f32 v42, v42, v34
    v_mul_f32 v43, v43, v35
    v_mul_f32 v44, s28, v40
    v_mul_f32 v45, s29, v40
    v_mul_f32 v46, s30, v40
    v_mul_f32 v47, s31, v40
    v_fmac_f32 v44, s32, v41
    v_fmac_f32 v45, s33, v41
    v_fmac_f32 v46, s34, v41
    v_fmac_f32 v47, s35, v41
    v_fmac_f32 v44, s36, v42
    v_fmac_f32 v45, s37, v42
    v_fmac_f32 v46, s38, v42
    v_fmac_f32 v47, s39, v42
    v_fmac_f32 v44, s40, v43
    v_fmac_f32 v45, s41, v43
    v_fmac_f32 v46, s42, v43
    v_fmac_f32 v47, s43, v43
    v_lshlrev_b32 v40, 16, v22
    v_and_b32 v41, 0xffff0000, v22
    v_lshlrev_b32 v42, 16, v23
    v_and_b32 v43, 0xffff0000, v23
    v_fmac_f32 v40, v44, v36
    v_fmac_f32 v41, v45, v37
    v_fmac_f32 v42, v46, v38
    v_fmac_f32 v43, v47, v39
    v_cvt_pk_bf16_f32 v44, v40, v41
    v_cvt_pk_bf16_f32 v45, v42, v43
    buffer_store_dwordx2 v[44:45], v17, s[16:19], 0 idxen
L_epi1_46:
gsm_acc_kernel_done:
    s_endpgm
.section .rodata,"a"
.p2align 6
.amdhsa_kernel gsm_part_kernel
  .amdhsa_next_free_vgpr 120
  .amdhsa_next_free_sgpr 102
  .amdhsa_accum_offset 120
  .amdhsa_group_segment_fixed_size 0
  .amdhsa_kernarg_size 112
  .amdhsa_user_sgpr_count 2
  .amdhsa_user_sgpr_kernarg_segment_ptr 1
  .amdhsa_system_sgpr_workgroup_id_x 1
  .amdhsa_float_denorm_mode_32 3
.end_amdhsa_kernel

.p2align 6
.amdhsa_kernel gsm_acc_kernel
  .amdhsa_next_free_vgpr 128
  .amdhsa_next_free_sgpr 102
  .amdhsa_accum_offset 128
  .amdhsa_group_segment_fixed_size 0
  .amdhsa_kernarg_size 112
  .amdhsa_user_sgpr_count 2
  .amdhsa_user_sgpr_kernarg_segment_ptr 1
  .amdhsa_system_sgpr_workgroup_id_x 1
  .amdhsa_float_denorm_mode_32 3
.end_amdhsa_kernel
```
